```python
import torch

def _softmax(x, axis=-1):
    return torch.softmax(x, dim=axis)
def _gelu(x):
    return torch.nn.functional.gelu(x, approximate="tanh")
def _silu(x):
    return torch.nn.functional.silu(x)
def _sigmoid(x):
    return torch.sigmoid(x)
def _layernorm(x, axis=-1, eps=1e-5):
    m = x.mean(dim=axis, keepdim=True)
    v = x.var(dim=axis, keepdim=True, unbiased=False)
    return (x - m) / torch.sqrt(v + eps)
def _scatter_add(tgt, idx, src, axis=0):
    return tgt.clone().index_add_(axis, idx, src)
def _segment_sum(src, seg, n):
    out = torch.zeros((n,) + src.shape[1:], dtype=src.dtype)
    return out.index_add_(0, seg, src)
def _pad(x, pw):
    flat = tuple(v for pair in reversed(pw) for v in pair)
    return torch.nn.functional.pad(x, flat)

kernel_name = 'concat_heads__mha_block_cached__sliding_block_cached__decode'

def setup_inputs():

    _w = (lambda a: (lambda t: t.to(torch.bfloat16) if t.is_floating_point() else t)(torch.as_tensor(a)))
    def _A_setup():
        B, Sq, D = 4, 1, 1024
        H, Sk, Dh = 32, 8192, 128
        return {
            "x": _w((lambda *s: torch.randn(*s, dtype=torch.bfloat16) * 0.8)(B, Sq, D)),
            "k_cache": _w((lambda *s: torch.randn(*s, dtype=torch.bfloat16) * 1.6)(B, H, Sk, Dh)),
            "v_cache": _w((lambda *s: torch.randn(*s, dtype=torch.bfloat16) * 0.2)(B, H, Sk, Dh)),
            "wq": _w((lambda *s: torch.randn(*s, dtype=torch.bfloat16) * 1.6)(D, H * Dh) * (D ** -0.5)),
            "wo": _w((lambda *s: torch.randn(*s, dtype=torch.bfloat16) * 0.2)(H * Dh, D) * ((H * Dh) ** -0.5)),
        }
    _A_in = _A_setup()

    def _B_setup():
        B, Sq, D = 4, 1, 1024
        Hq, Hkv, Sk, Dh = 32, 4, 8192, 128
        assert Hq % Hkv == 0, (Hq, Hkv)
        return {
            "x": _w((lambda *s: torch.randn(*s, dtype=torch.bfloat16) * 0.8)(B, Sq, D)),
            "k_cache": _w((lambda *s: torch.randn(*s, dtype=torch.bfloat16) * 1.6)(B, Hkv, Sk, Dh)),
            "v_cache": _w((lambda *s: torch.randn(*s, dtype=torch.bfloat16) * 0.2)(B, Hkv, Sk, Dh)),
            "wq": _w((lambda *s: torch.randn(*s, dtype=torch.bfloat16) * 1.6)(D, Hq * Dh) * (D ** -0.5)),
            "wo": _w((lambda *s: torch.randn(*s, dtype=torch.bfloat16) * 0.2)(Hq * Dh, D) * ((Hq * Dh) ** -0.5)),
        }
    _B_in = _B_setup()

    return {
        "A_x": _A_in["x"],
        "A_k_cache": _A_in["k_cache"],
        "A_v_cache": _A_in["v_cache"],
        "A_wq": _A_in["wq"],
        "A_wo": _A_in["wo"],
        "B_x": _B_in["x"],
        "B_k_cache": _B_in["k_cache"],
        "B_v_cache": _B_in["v_cache"],
        "B_wq": _B_in["wq"],
        "B_wo": _B_in["wo"],
    }

def reference(A_x, A_k_cache, A_v_cache, A_wq, A_wo, B_x, B_k_cache, B_v_cache, B_wq, B_wo):
    def _A_ref(x, k_cache, v_cache, wq, wo):
        B, Sq, D = x.shape
        H, Dh = 32, 128
        q = (lambda x, *d: x.permute(*d))((x @ wq).reshape(B, Sq, H, Dh), 0, 2, 1, 3)
        scores = torch.einsum("bhqd,bhkd->bhqk", q, k_cache) * (Dh ** -0.5)
        p = _softmax(scores, axis=-1)
        o = torch.einsum("bhqk,bhkd->bhqd", p, v_cache)
        return (lambda x, *d: x.permute(*d))(o, 0, 2, 1, 3).reshape(B, Sq, H * Dh) @ wo

    def _B_ref(x, k_cache, v_cache, wq, wo):
        B, Sq, D = x.shape
        Hq, Dh = 32, 128
        Hkv, Sk = k_cache.shape[1], k_cache.shape[2]
        W = min(4096, max(256, Sk // 4))
        rep = Hq // Hkv
        q = (lambda x, *d: x.permute(*d))((x @ wq).reshape(B, Sq, Hq, Dh), 0, 2, 1, 3)
        k = (lambda x, n, axis: torch.repeat_interleave(x, n, dim=axis))(k_cache[:, :, Sk - W:, :], rep, axis=1)
        v = (lambda x, n, axis: torch.repeat_interleave(x, n, dim=axis))(v_cache[:, :, Sk - W:, :], rep, axis=1)
        scores = torch.einsum("bhqd,bhkd->bhqk", q, k) * (Dh ** -0.5)
        p = _softmax(scores, axis=-1)
        o = torch.einsum("bhqk,bhkd->bhqd", p, v)
        return (lambda x, *d: x.permute(*d))(o, 0, 2, 1, 3).reshape(B, Sq, Hq * Dh) @ wo

    a = _A_ref(A_x, A_k_cache, A_v_cache, A_wq, A_wo)
    b = _B_ref(B_x, B_k_cache, B_v_cache, B_wq, B_wo)
    return torch.concatenate([a, b], axis=-1)
```

```asm
; @launch grid=(256,1,1) block=(320,1,1) lds=156416
.amdgcn_target "amdgcn-amd-amdhsa--gfx950"
.text
.globl concat_heads__mha_block_cached__sliding_block_cached__decode_kernel
.p2align 8
.type concat_heads__mha_block_cached__sliding_block_cached__decode_kernel,@function
concat_heads__mha_block_cached__sliding_block_cached__decode_kernel:
  s_cmp_ge_u32 s2, 256
  s_cbranch_scc1 L_end
  s_load_dwordx16 s[4:19], s[0:1], 0
  s_load_dwordx8 s[20:27], s[0:1], 64
  s_load_dwordx2 s[28:29], s[0:1], 96
  v_lshrrev_b32 v4, 6, v0
  v_and_b32 v1, 63, v0
  v_readfirstlane_b32 s3, v4
  v_lshrrev_b32 v2, 4, v1
  v_and_b32 v3, 15, v1
  s_lshr_b32 s91, s2, 3
  s_and_b32 s92, s2, 7
  s_lshr_b32 s93, s2, 6
  s_bfe_u32 s94, s2, 0x50001
  s_and_b32 s95, s2, 1
  s_mov_b32 s67, 0x3e0293ee
  s_cmp_eq_u32 s3, 4
  s_cbranch_scc1 L_helper
  s_setprio 1
  v_lshrrev_b32 v4, 3, v3
  v_lshlrev_b32 v5, 11, v4
  v_lshl_add_u32 v5, v2, 5, v5
  v_lshlrev_b32 v67, 17, v2
  v_lshl_add_u32 v67, v3, 4, v67
  s_and_b32 s60, s2, 3
  s_lshl_b32 s60, s60, 9
  s_lshl_b32 s61, s3, 7
  s_add_u32 s60, s60, s61
  s_add_u32 s61, s60, 4096
  s_lshl_b32 s62, s60, 12
  s_lshl_b32 s63, s91, 8
  s_add_u32 s62, s62, s63
  s_mov_b32 s42, 8192
  s_mov_b32 s43, 0x00020000
  s_mov_b32 s46, 0x800000
  s_mov_b32 s47, 0x00020000
  s_lshr_b32 s63, s2, 1
  s_xor_b32 s63, s63, s2
  s_bitcmp1_b32 s63, 2
  s_waitcnt lgkmcnt(0)
  s_cselect_b32 s44, s20, s10
  s_cselect_b32 s45, s21, s11
  s_cselect_b32 s40, s14, s4
  s_cselect_b32 s41, s15, s5
  buffer_load_dwordx4 a[0:3], v67, s[44:47], s62 offen nt
  s_add_u32 s62, s62, 8192
  buffer_load_dwordx4 a[4:7], v67, s[44:47], s62 offen nt
  s_add_u32 s62, s62, 8192
  buffer_load_dwordx4 a[8:11], v67, s[44:47], s62 offen nt
  s_add_u32 s62, s62, 8192
  buffer_load_dwordx4 a[12:15], v67, s[44:47], s62 offen nt
  s_add_u32 s62, s62, 8192
  buffer_load_dwordx4 a[16:19], v67, s[44:47], s62 offen nt
  s_add_u32 s62, s62, 8192
  buffer_load_dwordx4 a[20:23], v67, s[44:47], s62 offen nt
  s_add_u32 s62, s62, 8192
  buffer_load_dwordx4 a[24:27], v67, s[44:47], s62 offen nt
  s_add_u32 s62, s62, 8192
  buffer_load_dwordx4 a[28:31], v67, s[44:47], s62 offen nt
  s_add_u32 s62, s62, 8192
  buffer_load_dwordx4 v[26:29], v5, s[40:43], s60 offen
  buffer_load_dwordx4 v[30:33], v5, s[40:43], s61 offen
  buffer_load_dwordx4 v[90:93], v5, s[40:43], s60 offen offset:16
  buffer_load_dwordx4 v[94:97], v5, s[40:43], s61 offen offset:16
  s_mov_b32 s32, s6
  s_mov_b32 s33, s7
  s_mov_b32 s34, 0x10000000
  s_mov_b32 s35, 0x00020000
  s_mov_b32 s36, s8
  s_mov_b32 s37, s9
  s_mov_b32 s38, 0x10000000
  s_mov_b32 s39, 0x00020000
  s_mov_b32 s48, s28
  s_mov_b32 s49, s29
  s_mov_b32 s50, 0x800000
  s_mov_b32 s51, 0x00020000
  s_mov_b32 s40, s16
  s_mov_b32 s41, s17
  s_mov_b32 s42, 0x2000000
  s_mov_b32 s43, 0x00020000
  s_mov_b32 s52, s18
  s_mov_b32 s53, s19
  s_mov_b32 s54, 0x2000000
  s_mov_b32 s55, 0x00020000
  s_cmp_ge_u32 s2, 128
  s_cselect_b32 s56, s22, s12
  s_cselect_b32 s57, s23, s13
  s_mov_b32 s58, 0x800000
  s_mov_b32 s59, 0x00020000
  v_lshrrev_b32 v7, 2, v3
  v_lshlrev_b32 v20, 8, v7
  v_lshl_add_u32 v20, v2, 6, v20
  v_and_b32 v5, 3, v3
  v_lshl_add_u32 v20, v5, 4, v20
  v_lshl_add_u32 v6, v2, 1, v4
  v_lshlrev_b32 v21, 8, v6
  v_and_b32 v5, 7, v3
  v_lshl_add_u32 v21, v5, 4, v21
  s_lshl_b32 s60, s3, 1
  v_lshrrev_b32 v98, 1, v2
  v_add_u32 v98, s60, v98
  v_xor_b32 v98, v98, v3
  v_lshlrev_b32 v98, 4, v98
  v_lshl_add_u32 v98, v2, 11, v98
  s_lshr_b32 s65, s2, 1
  s_lshl_b32 s65, s65, 21
  s_lshl_b32 s60, s95, 14
  s_add_u32 s65, s65, s60
  s_lshl_b32 s60, s3, 12
  s_add_u32 s65, s65, s60
  s_mov_b32 s66, s65
  s_add_u32 s60, s60, 131072
  v_lshl_add_u32 v22, v7, 2, v2
  v_lshl_add_u32 v22, v22, 2, s60
  v_lshl_add_u32 v23, v6, 2, s60
  v_lshl_add_u32 v89, v1, 4, s60
  v_mov_b32 v24, 0xff800000
  v_lshrrev_b32 v4, 1, v3
  v_lshlrev_b32 v66, 8, v4
  v_lshl_add_u32 v66, v2, 5, v66
  v_and_b32 v4, 1, v3
  v_lshl_add_u32 v66, v4, 4, v66
  v_lshlrev_b32 v64, 9, v2
  v_lshl_add_u32 v64, v3, 4, v64
  s_lshr_b32 s30, s2, 7
  s_lshl_b32 s30, s30, 3
  s_add_u32 s30, s30, s92
  s_lshl_b32 s30, s30, 21
  s_and_b32 s60, s91, 15
  s_lshl_b32 s60, s60, 15
  s_add_u32 s30, s30, s60
  s_lshl_b32 s69, s3, 13
  s_add_u32 s30, s30, s69
  s_add_u32 s30, s30, 1572864
  s_and_b32 s63, s91, 15
  s_lshl_b32 s63, s63, 19
  s_lshl_b32 s60, s92, 8
  s_add_u32 s63, s63, s60
  s_add_u32 s6, s63, s69
  s_lshl_b32 s7, s3, 10
  s_bfe_u32 s61, s2, 0x20003
  s_lshl_b32 s61, s61, 11
  s_mov_b32 s70, 0x3030303
  s_mov_b32 s71, 0x3030303
  s_mov_b32 s72, 0xc0c0c0c
  s_mov_b32 s73, 0xc0c0c0c
  s_mov_b32 s74, 0x30303030
  s_mov_b32 s75, 0x30303030
  s_mov_b32 s76, 0xc0c0c0c0
  s_mov_b32 s77, 0xc0c0c0c0
  s_mov_b32 s86, 0xaaaaaaaa
  s_mov_b32 s87, 0xaaaaaaaa
  v_mov_b32 v4, 0x0c0c0100
  v_mov_b32 v5, 0x01000c0c
  v_cndmask_b32 v6, v4, v5, s[86:87]
  v_mov_b32 v4, 0x0c0c0302
  v_mov_b32 v5, 0x03020c0c
  v_cndmask_b32 v7, v4, v5, s[86:87]
  v_mov_b32 v4, 0x0c0c0c0c
  v_cndmask_b32 v8, v4, v6, s[70:71]
  v_cndmask_b32 v9, v4, v7, s[70:71]
  v_cndmask_b32 v10, v4, v6, s[72:73]
  v_cndmask_b32 v11, v4, v7, s[72:73]
  v_cndmask_b32 v12, v4, v6, s[74:75]
  v_cndmask_b32 v13, v4, v7, s[74:75]
  v_cndmask_b32 v14, v4, v6, s[76:77]
  v_cndmask_b32 v15, v4, v7, s[76:77]
  v_mov_b32 v4, 0x0000ffff
  v_mov_b32 v5, 0xffff0000
  v_cndmask_b32 v6, v4, v5, s[86:87]
  v_cndmask_b32 v16, 0, v6, s[70:71]
  v_cndmask_b32 v17, 0, v6, s[72:73]
  v_cndmask_b32 v18, 0, v6, s[74:75]
  v_cndmask_b32 v19, 0, v6, s[76:77]
  s_waitcnt vmcnt(8)
  buffer_load_dwordx4 a[32:35], v67, s[44:47], s62 offen nt
  s_add_u32 s62, s62, 8192
  s_waitcnt vmcnt(8)
  buffer_load_dwordx4 a[36:39], v67, s[44:47], s62 offen nt
  s_add_u32 s62, s62, 8192
  s_waitcnt vmcnt(8)
  buffer_load_dwordx4 a[40:43], v67, s[44:47], s62 offen nt
  s_add_u32 s62, s62, 8192
  s_waitcnt vmcnt(8)
  buffer_load_dwordx4 a[44:47], v67, s[44:47], s62 offen nt
  s_add_u32 s62, s62, 8192
  s_waitcnt vmcnt(8)
  buffer_load_dwordx4 a[48:51], v67, s[44:47], s62 offen nt
  s_add_u32 s62, s62, 8192
  s_waitcnt vmcnt(8)
  buffer_load_dwordx4 a[52:55], v67, s[44:47], s62 offen nt
  s_add_u32 s62, s62, 8192
  s_waitcnt vmcnt(8)
  buffer_load_dwordx4 a[56:59], v67, s[44:47], s62 offen nt
  s_add_u32 s62, s62, 8192
  s_waitcnt vmcnt(8)
  buffer_load_dwordx4 a[60:63], v67, s[44:47], s62 offen nt
  s_add_u32 s62, s62, 8192
  s_add_u32 s63, s30, s61
  s_add_u32 s64, s69, s61
  s_add_u32 m0, s64, 98304
  s_waitcnt vmcnt(6)
  buffer_load_dwordx4 v66, s[40:43], s63 offen nt lds
  v_perm_b32 v34, v26, v26, v8
  v_perm_b32 v35, v26, v26, v10
  v_perm_b32 v36, v26, v26, v12
  v_perm_b32 v37, v26, v26, v14
  s_nop 1
  v_mfma_f32_16x16x32_bf16 v[42:45], a[0:3], v[34:37], 0
  v_perm_b32 v38, v30, v30, v8
  v_perm_b32 v39, v30, v30, v10
  v_perm_b32 v40, v30, v30, v12
  v_perm_b32 v41, v30, v30, v14
  s_nop 1
  v_mfma_f32_16x16x32_bf16 v[46:49], a[0:3], v[38:41], 0
  v_perm_b32 v34, v26, v26, v9
  v_perm_b32 v35, v26, v26, v11
  v_perm_b32 v36, v26, v26, v13
  v_perm_b32 v37, v26, v26, v15
  s_nop 1
  v_mfma_f32_16x16x32_bf16 v[42:45], a[4:7], v[34:37], v[42:45]
  v_perm_b32 v38, v30, v30, v9
  v_perm_b32 v39, v30, v30, v11
  v_perm_b32 v40, v30, v30, v13
  v_perm_b32 v41, v30, v30, v15
  s_nop 1
  v_mfma_f32_16x16x32_bf16 v[46:49], a[4:7], v[38:41], v[46:49]
  v_perm_b32 v34, v27, v27, v8
  v_perm_b32 v35, v27, v27, v10
  v_perm_b32 v36, v27, v27, v12
  v_perm_b32 v37, v27, v27, v14
  s_nop 1
  v_mfma_f32_16x16x32_bf16 v[42:45], a[8:11], v[34:37], v[42:45]
  v_perm_b32 v38, v31, v31, v8
  v_perm_b32 v39, v31, v31, v10
  v_perm_b32 v40, v31, v31, v12
  v_perm_b32 v41, v31, v31, v14
  s_nop 1
  v_mfma_f32_16x16x32_bf16 v[46:49], a[8:11], v[38:41], v[46:49]
  v_perm_b32 v34, v27, v27, v9
  v_perm_b32 v35, v27, v27, v11
  v_perm_b32 v36, v27, v27, v13
  v_perm_b32 v37, v27, v27, v15
  s_nop 1
  v_mfma_f32_16x16x32_bf16 v[42:45], a[12:15], v[34:37], v[42:45]
  v_perm_b32 v38, v31, v31, v9
  v_perm_b32 v39, v31, v31, v11
  v_perm_b32 v40, v31, v31, v13
  v_perm_b32 v41, v31, v31, v15
  s_nop 1
  v_mfma_f32_16x16x32_bf16 v[46:49], a[12:15], v[38:41], v[46:49]
  v_perm_b32 v34, v28, v28, v8
  v_perm_b32 v35, v28, v28, v10
  v_perm_b32 v36, v28, v28, v12
  v_perm_b32 v37, v28, v28, v14
  s_nop 1
  v_mfma_f32_16x16x32_bf16 v[42:45], a[16:19], v[34:37], v[42:45]
  v_perm_b32 v38, v32, v32, v8
  v_perm_b32 v39, v32, v32, v10
  v_perm_b32 v40, v32, v32, v12
  v_perm_b32 v41, v32, v32, v14
  s_nop 1
  v_mfma_f32_16x16x32_bf16 v[46:49], a[16:19], v[38:41], v[46:49]
  v_perm_b32 v34, v28, v28, v9
  v_perm_b32 v35, v28, v28, v11
  v_perm_b32 v36, v28, v28, v13
  v_perm_b32 v37, v28, v28, v15
  s_nop 1
  v_mfma_f32_16x16x32_bf16 v[42:45], a[20:23], v[34:37], v[42:45]
  v_perm_b32 v38, v32, v32, v9
  v_perm_b32 v39, v32, v32, v11
  v_perm_b32 v40, v32, v32, v13
  v_perm_b32 v41, v32, v32, v15
  s_nop 1
  v_mfma_f32_16x16x32_bf16 v[46:49], a[20:23], v[38:41], v[46:49]
  v_perm_b32 v34, v29, v29, v8
  v_perm_b32 v35, v29, v29, v10
  v_perm_b32 v36, v29, v29, v12
  v_perm_b32 v37, v29, v29, v14
  s_nop 1
  v_mfma_f32_16x16x32_bf16 v[42:45], a[24:27], v[34:37], v[42:45]
  v_perm_b32 v38, v33, v33, v8
  v_perm_b32 v39, v33, v33, v10
  v_perm_b32 v40, v33, v33, v12
  v_perm_b32 v41, v33, v33, v14
  s_nop 1
  v_mfma_f32_16x16x32_bf16 v[46:49], a[24:27], v[38:41], v[46:49]
  v_perm_b32 v34, v29, v29, v9
  v_perm_b32 v35, v29, v29, v11
  v_perm_b32 v36, v29, v29, v13
  v_perm_b32 v37, v29, v29, v15
  s_nop 1
  v_mfma_f32_16x16x32_bf16 v[42:45], a[28:31], v[34:37], v[42:45]
  v_perm_b32 v38, v33, v33, v9
  v_perm_b32 v39, v33, v33, v11
  v_perm_b32 v40, v33, v33, v13
  v_perm_b32 v41, v33, v33, v15
  s_nop 1
  v_mfma_f32_16x16x32_bf16 v[46:49], a[28:31], v[38:41], v[46:49]
  v_perm_b32 v34, v90, v90, v8
  v_perm_b32 v35, v90, v90, v10
  v_perm_b32 v36, v90, v90, v12
  v_perm_b32 v37, v90, v90, v14
  s_nop 1
  v_mfma_f32_16x16x32_bf16 v[42:45], a[32:35], v[34:37], v[42:45]
  v_perm_b32 v38, v94, v94, v8
  v_perm_b32 v39, v94, v94, v10
  v_perm_b32 v40, v94, v94, v12
  v_perm_b32 v41, v94, v94, v14
  s_nop 1
  v_mfma_f32_16x16x32_bf16 v[46:49], a[32:35], v[38:41], v[46:49]
  v_perm_b32 v34, v90, v90, v9
  v_perm_b32 v35, v90, v90, v11
  v_perm_b32 v36, v90, v90, v13
  v_perm_b32 v37, v90, v90, v15
  s_nop 1
  v_mfma_f32_16x16x32_bf16 v[42:45], a[36:39], v[34:37], v[42:45]
  v_perm_b32 v38, v94, v94, v9
  v_perm_b32 v39, v94, v94, v11
  v_perm_b32 v40, v94, v94, v13
  v_perm_b32 v41, v94, v94, v15
  s_nop 1
  v_mfma_f32_16x16x32_bf16 v[46:49], a[36:39], v[38:41], v[46:49]
  s_add_u32 s63, s63, 128
  s_add_u32 m0, s64, 99328
  s_add_u32 s61, s61, 2048
  s_and_b32 s61, s61, 8191
  s_waitcnt vmcnt(6)
  buffer_load_dwordx4 v66, s[40:43], s63 offen nt lds
  v_perm_b32 v34, v91, v91, v8
  v_perm_b32 v35, v91, v91, v10
  v_perm_b32 v36, v91, v91, v12
  v_perm_b32 v37, v91, v91, v14
  s_nop 1
  v_mfma_f32_16x16x32_bf16 v[42:45], a[40:43], v[34:37], v[42:45]
  v_perm_b32 v38, v95, v95, v8
  v_perm_b32 v39, v95, v95, v10
  v_perm_b32 v40, v95, v95, v12
  v_perm_b32 v41, v95, v95, v14
  s_nop 1
  v_mfma_f32_16x16x32_bf16 v[46:49], a[40:43], v[38:41], v[46:49]
  s_add_u32 s63, s30, s61
  s_add_u32 s64, s69, s61
  s_add_u32 m0, s64, 98304
  s_waitcnt vmcnt(6)
  buffer_load_dwordx4 v66, s[40:43], s63 offen nt lds
  v_perm_b32 v34, v91, v91, v9
  v_perm_b32 v35, v91, v91, v11
  v_perm_b32 v36, v91, v91, v13
  v_perm_b32 v37, v91, v91, v15
  s_nop 1
  v_mfma_f32_16x16x32_bf16 v[42:45], a[44:47], v[34:37], v[42:45]
  v_perm_b32 v38, v95, v95, v9
  v_perm_b32 v39, v95, v95, v11
  v_perm_b32 v40, v95, v95, v13
  v_perm_b32 v41, v95, v95, v15
  s_nop 1
  v_mfma_f32_16x16x32_bf16 v[46:49], a[44:47], v[38:41], v[46:49]
  s_add_u32 s63, s63, 128
  s_add_u32 m0, s64, 99328
  s_add_u32 s61, s61, 2048
  s_and_b32 s61, s61, 8191
  s_waitcnt vmcnt(6)
  buffer_load_dwordx4 v66, s[40:43], s63 offen nt lds
  v_perm_b32 v34, v92, v92, v8
  v_perm_b32 v35, v92, v92, v10
  v_perm_b32 v36, v92, v92, v12
  v_perm_b32 v37, v92, v92, v14
  s_nop 1
  v_mfma_f32_16x16x32_bf16 v[42:45], a[48:51], v[34:37], v[42:45]
  v_perm_b32 v38, v96, v96, v8
  v_perm_b32 v39, v96, v96, v10
  v_perm_b32 v40, v96, v96, v12
  v_perm_b32 v41, v96, v96, v14
  s_nop 1
  v_mfma_f32_16x16x32_bf16 v[46:49], a[48:51], v[38:41], v[46:49]
  s_add_u32 s63, s30, s61
  s_add_u32 s64, s69, s61
  s_add_u32 m0, s64, 98304
  s_waitcnt vmcnt(6)
  buffer_load_dwordx4 v66, s[40:43], s63 offen nt lds
  v_perm_b32 v34, v92, v92, v9
  v_perm_b32 v35, v92, v92, v11
  v_perm_b32 v36, v92, v92, v13
  v_perm_b32 v37, v92, v92, v15
  s_nop 1
  v_mfma_f32_16x16x32_bf16 v[42:45], a[52:55], v[34:37], v[42:45]
  v_perm_b32 v38, v96, v96, v9
  v_perm_b32 v39, v96, v96, v11
  v_perm_b32 v40, v96, v96, v13
  v_perm_b32 v41, v96, v96, v15
  s_nop 1
  v_mfma_f32_16x16x32_bf16 v[46:49], a[52:55], v[38:41], v[46:49]
  s_add_u32 s63, s63, 128
  s_add_u32 m0, s64, 99328
  s_add_u32 s61, s61, 2048
  s_and_b32 s61, s61, 8191
  s_waitcnt vmcnt(6)
  buffer_load_dwordx4 v66, s[40:43], s63 offen nt lds
  v_perm_b32 v34, v93, v93, v8
  v_perm_b32 v35, v93, v93, v10
  v_perm_b32 v36, v93, v93, v12
  v_perm_b32 v37, v93, v93, v14
  s_nop 1
  v_mfma_f32_16x16x32_bf16 v[42:45], a[56:59], v[34:37], v[42:45]
  v_perm_b32 v38, v97, v97, v8
  v_perm_b32 v39, v97, v97, v10
  v_perm_b32 v40, v97, v97, v12
  v_perm_b32 v41, v97, v97, v14
  s_nop 1
  v_mfma_f32_16x16x32_bf16 v[46:49], a[56:59], v[38:41], v[46:49]
  s_add_u32 s63, s30, s61
  s_add_u32 s64, s69, s61
  s_add_u32 m0, s64, 98304
  s_waitcnt vmcnt(6)
  buffer_load_dwordx4 v66, s[40:43], s63 offen nt lds
  v_perm_b32 v34, v93, v93, v9
  v_perm_b32 v35, v93, v93, v11
  v_perm_b32 v36, v93, v93, v13
  v_perm_b32 v37, v93, v93, v15
  s_nop 1
  v_mfma_f32_16x16x32_bf16 v[42:45], a[60:63], v[34:37], v[42:45]
  v_perm_b32 v38, v97, v97, v9
  v_perm_b32 v39, v97, v97, v11
  v_perm_b32 v40, v97, v97, v13
  v_perm_b32 v41, v97, v97, v15
  s_nop 1
  v_mfma_f32_16x16x32_bf16 v[46:49], a[60:63], v[38:41], v[46:49]
  s_nop 0
  ds_write_b128 v89, v[42:45] offset:0
  s_nop 5
  ds_write_b128 v89, v[46:49] offset:1024
  s_waitcnt lgkmcnt(0)
  s_barrier
  s_add_u32 s63, s63, 128
  s_add_u32 m0, s64, 99328
  s_add_u32 s61, s61, 2048
  s_and_b32 s61, s61, 8191
  s_waitcnt vmcnt(6)
  buffer_load_dwordx4 v66, s[40:43], s63 offen nt lds
  s_add_u32 s63, s30, s61
  s_add_u32 s64, s69, s61
  s_add_u32 m0, s64, 65536
  s_waitcnt vmcnt(6)
  buffer_load_dwordx4 v64, s[52:55], s63 offen nt lds
  s_add_u32 s63, s63, 256
  s_add_u32 m0, s64, 66560
  s_add_u32 s61, s61, 2048
  s_and_b32 s61, s61, 8191
  s_waitcnt vmcnt(6)
  buffer_load_dwordx4 v64, s[52:55], s63 offen nt lds
  s_add_u32 s63, s30, s61
  s_add_u32 s64, s69, s61
  s_add_u32 m0, s64, 65536
  s_waitcnt vmcnt(6)
  buffer_load_dwordx4 v64, s[52:55], s63 offen nt lds
  s_add_u32 s63, s63, 256
  s_add_u32 m0, s64, 66560
  s_add_u32 s61, s61, 2048
  s_and_b32 s61, s61, 8191
  s_waitcnt vmcnt(6)
  buffer_load_dwordx4 v64, s[52:55], s63 offen nt lds
  s_add_u32 s63, s30, s61
  s_add_u32 s64, s69, s61
  s_add_u32 m0, s64, 65536
  s_waitcnt vmcnt(6)
  buffer_load_dwordx4 v64, s[52:55], s63 offen nt lds
  s_add_u32 s63, s63, 256
  s_add_u32 m0, s64, 66560
  s_add_u32 s61, s61, 2048
  s_and_b32 s61, s61, 8191
  s_waitcnt vmcnt(6)
  buffer_load_dwordx4 v64, s[52:55], s63 offen nt lds
  s_add_u32 s63, s30, s61
  s_add_u32 s64, s69, s61
  s_add_u32 m0, s64, 65536
  s_waitcnt vmcnt(6)
  buffer_load_dwordx4 v64, s[52:55], s63 offen nt lds
  s_add_u32 s63, s63, 256
  s_add_u32 m0, s64, 66560
  s_add_u32 s61, s61, 2048
  s_and_b32 s61, s61, 8191
  s_waitcnt vmcnt(6)
  buffer_load_dwordx4 v64, s[52:55], s63 offen nt lds
  s_add_u32 m0, s7, 0
  s_add_u32 s63, s6, 0
  s_waitcnt vmcnt(6)
  buffer_load_dwordx4 v98, s[56:59], s63 offen nt lds
  s_add_u32 m0, s7, 4096
  s_add_u32 s63, s6, 32768
  v_xor_b32 v99, 128, v98
  s_waitcnt vmcnt(6)
  buffer_load_dwordx4 v99, s[56:59], s63 offen nt lds
  s_add_u32 m0, s7, 8192
  s_add_u32 s63, s6, 65536
  s_waitcnt vmcnt(6)
  buffer_load_dwordx4 v98, s[56:59], s63 offen nt lds
  s_add_u32 m0, s7, 12288
  s_add_u32 s63, s6, 98304
  v_xor_b32 v99, 128, v98
  s_waitcnt vmcnt(6)
  buffer_load_dwordx4 v99, s[56:59], s63 offen nt lds
  s_add_u32 m0, s7, 32768
  s_add_u32 s63, s6, 262144
  v_xor_b32 v99, 32, v98
  s_waitcnt vmcnt(6)
  buffer_load_dwordx4 v99, s[56:59], s63 offen nt lds
  s_add_u32 m0, s7, 36864
  s_add_u32 s63, s6, 294912
  v_xor_b32 v99, 160, v98
  s_waitcnt vmcnt(6)
  buffer_load_dwordx4 v99, s[56:59], s63 offen nt lds
  s_add_u32 m0, s7, 40960
  s_add_u32 s63, s6, 327680
  v_xor_b32 v99, 32, v98
  s_waitcnt vmcnt(6)
  buffer_load_dwordx4 v99, s[56:59], s63 offen nt lds
  s_add_u32 m0, s7, 45056
  s_add_u32 s63, s6, 360448
  v_xor_b32 v99, 160, v98
  s_waitcnt vmcnt(6)
  buffer_load_dwordx4 v99, s[56:59], s63 offen nt lds
  s_mov_b32 s52, s24
  s_mov_b32 s53, s25
  s_mov_b32 s54, 0x4000
  s_mov_b32 s55, 0x00020000
  s_waitcnt vmcnt(4)
  buffer_load_dwordx4 a[64:67], v20, s[32:35], s65 offen offset:0 nt
  s_waitcnt vmcnt(4)
  buffer_load_dwordx4 a[68:71], v20, s[32:35], s65 offen offset:1024 nt
  s_waitcnt vmcnt(4)
  buffer_load_dwordx4 a[72:75], v20, s[32:35], s65 offen offset:2048 nt
  s_waitcnt vmcnt(4)
  buffer_load_dwordx4 a[76:79], v20, s[32:35], s65 offen offset:3072 nt
  s_add_u32 s65, s65, 32768
  s_waitcnt vmcnt(4)
  buffer_load_dwordx4 a[80:83], v20, s[32:35], s65 offen offset:0 nt
  s_waitcnt vmcnt(4)
  buffer_load_dwordx4 a[84:87], v20, s[32:35], s65 offen offset:1024 nt
  s_waitcnt vmcnt(4)
  buffer_load_dwordx4 a[88:91], v20, s[32:35], s65 offen offset:2048 nt
  s_waitcnt vmcnt(4)
  buffer_load_dwordx4 a[92:95], v20, s[32:35], s65 offen offset:3072 nt
  s_add_u32 s65, s65, 32768
  s_waitcnt vmcnt(4)
  buffer_load_dwordx4 a[96:99], v20, s[32:35], s65 offen offset:0 nt
  s_waitcnt vmcnt(4)
  buffer_load_dwordx4 a[100:103], v20, s[32:35], s65 offen offset:1024 nt
  s_waitcnt vmcnt(4)
  buffer_load_dwordx4 a[104:107], v20, s[32:35], s65 offen offset:2048 nt
  s_waitcnt vmcnt(4)
  buffer_load_dwordx4 a[108:111], v20, s[32:35], s65 offen offset:3072 nt
  s_add_u32 s65, s65, 32768
  s_waitcnt vmcnt(4)
  buffer_load_dwordx4 a[112:115], v20, s[32:35], s65 offen offset:0 nt
  s_waitcnt vmcnt(4)
  buffer_load_dwordx4 a[116:119], v20, s[32:35], s65 offen offset:1024 nt
  s_waitcnt vmcnt(4)
  buffer_load_dwordx4 a[120:123], v20, s[32:35], s65 offen offset:2048 nt
  s_waitcnt vmcnt(4)
  buffer_load_dwordx4 a[124:127], v20, s[32:35], s65 offen offset:3072 nt
  s_add_u32 s65, s65, 32768
  s_waitcnt vmcnt(4)
  buffer_load_dwordx4 a[0:3], v20, s[32:35], s65 offen offset:0 nt
  s_waitcnt vmcnt(4)
  buffer_load_dwordx4 a[4:7], v20, s[32:35], s65 offen offset:1024 nt
  s_waitcnt vmcnt(4)
  buffer_load_dwordx4 a[8:11], v20, s[32:35], s65 offen offset:2048 nt
  s_waitcnt vmcnt(4)
  buffer_load_dwordx4 a[12:15], v20, s[32:35], s65 offen offset:3072 nt
  s_add_u32 s65, s65, 32768
  s_waitcnt vmcnt(4)
  buffer_load_dwordx4 a[16:19], v20, s[32:35], s65 offen offset:0 nt
  s_waitcnt vmcnt(4)
  buffer_load_dwordx4 a[20:23], v20, s[32:35], s65 offen offset:1024 nt
  s_waitcnt vmcnt(4)
  buffer_load_dwordx4 a[24:27], v20, s[32:35], s65 offen offset:2048 nt
  s_waitcnt vmcnt(4)
  buffer_load_dwordx4 a[28:31], v20, s[32:35], s65 offen offset:3072 nt
  s_add_u32 s65, s65, 32768
  s_waitcnt vmcnt(4)
  buffer_load_dwordx4 a[32:35], v20, s[32:35], s65 offen offset:0 nt
  s_waitcnt vmcnt(4)
  buffer_load_dwordx4 a[36:39], v20, s[32:35], s65 offen offset:1024 nt
  s_waitcnt vmcnt(4)
  buffer_load_dwordx4 a[40:43], v20, s[32:35], s65 offen offset:2048 nt
  s_waitcnt vmcnt(4)
  buffer_load_dwordx4 a[44:47], v20, s[32:35], s65 offen offset:3072 nt
  s_add_u32 s65, s65, 32768
  s_barrier
  v_and_b32 v4, 3, v3
  v_lshl_add_u32 v4, v2, 2, v4
  v_lshlrev_b32 v4, 4, v4
  v_add_u32 v4, 155648, v4
  ds_read_b128 v[34:37], v4
  s_waitcnt vmcnt(4)
  buffer_load_dwordx4 a[48:51], v20, s[32:35], s65 offen offset:0 nt
  s_mov_b32 s70, 0xf000f
  s_mov_b32 s71, 0xf000f
  s_mov_b32 s72, 0xf000f0
  s_mov_b32 s73, 0xf000f0
  s_mov_b32 s74, 0xf000f00
  s_mov_b32 s75, 0xf000f00
  s_mov_b32 s76, 0xf000f000
  s_mov_b32 s77, 0xf000f000
  s_waitcnt lgkmcnt(0)
  v_cndmask_b32 v8, 0, v34, s[70:71]
  v_cndmask_b32 v9, 0, v35, s[70:71]
  v_cndmask_b32 v10, 0, v36, s[70:71]
  v_cndmask_b32 v11, 0, v37, s[70:71]
  v_cndmask_b32 v12, 0, v34, s[72:73]
  v_cndmask_b32 v13, 0, v35, s[72:73]
  v_cndmask_b32 v14, 0, v36, s[72:73]
  v_cndmask_b32 v15, 0, v37, s[72:73]
  v_cndmask_b32 v26, 0, v34, s[74:75]
  v_cndmask_b32 v27, 0, v35, s[74:75]
  v_cndmask_b32 v28, 0, v36, s[74:75]
  v_cndmask_b32 v29, 0, v37, s[74:75]
  v_cndmask_b32 v30, 0, v34, s[76:77]
  v_cndmask_b32 v31, 0, v35, s[76:77]
  v_cndmask_b32 v32, 0, v36, s[76:77]
  v_cndmask_b32 v33, 0, v37, s[76:77]
  s_waitcnt vmcnt(4)
  buffer_load_dwordx4 a[52:55], v20, s[32:35], s65 offen offset:1024 nt
  v_mfma_f32_16x16x32_bf16 v[42:45], a[0:3], v[8:11], 0
  v_mfma_f32_16x16x32_bf16 v[42:45], a[4:7], v[12:15], v[42:45]
  v_mfma_f32_16x16x32_bf16 v[42:45], a[8:11], v[26:29], v[42:45]
  v_mfma_f32_16x16x32_bf16 v[42:45], a[12:15], v[30:33], v[42:45]
  s_waitcnt vmcnt(4)
  buffer_load_dwordx4 a[56:59], v20, s[32:35], s65 offen offset:2048 nt
  v_mfma_f32_16x16x32_bf16 v[46:49], a[16:19], v[8:11], 0
  v_mfma_f32_16x16x32_bf16 v[46:49], a[20:23], v[12:15], v[46:49]
  v_mfma_f32_16x16x32_bf16 v[46:49], a[24:27], v[26:29], v[46:49]
  v_mfma_f32_16x16x32_bf16 v[46:49], a[28:31], v[30:33], v[46:49]
  s_nop 1
  v_mov_b32_dpp v25, v42 quad_perm:[0,0,0,0] row_mask:0xf bank_mask:0xf
  v_add_f32_dpp v25, v43, v25 quad_perm:[1,1,1,1] row_mask:0xf bank_mask:0xf
  v_add_f32_dpp v25, v44, v25 quad_perm:[2,2,2,2] row_mask:0xf bank_mask:0xf
  v_add_f32_dpp v25, v45, v25 quad_perm:[3,3,3,3] row_mask:0xf bank_mask:0xf
  v_max_f32 v24, v24, v25
  ds_write_b32 v22, v25 offset:256
  s_waitcnt vmcnt(4)
  buffer_load_dwordx4 a[60:63], v20, s[32:35], s65 offen offset:3072 nt
  s_add_u32 s65, s65, 32768
  v_mfma_f32_16x16x32_bf16 v[42:45], a[32:35], v[8:11], 0
  v_mov_b32_dpp v25, v46 quad_perm:[0,0,0,0] row_mask:0xf bank_mask:0xf
  v_add_f32_dpp v25, v47, v25 quad_perm:[1,1,1,1] row_mask:0xf bank_mask:0xf
  v_add_f32_dpp v25, v48, v25 quad_perm:[2,2,2,2] row_mask:0xf bank_mask:0xf
  v_add_f32_dpp v25, v49, v25 quad_perm:[3,3,3,3] row_mask:0xf bank_mask:0xf
  v_max_f32 v24, v24, v25
  ds_write_b32 v22, v25 offset:320
  v_mfma_f32_16x16x32_bf16 v[50:53], a[64:67], v[8:11], 0
  v_mfma_f32_16x16x32_bf16 v[50:53], a[68:71], v[12:15], v[50:53]
  v_mfma_f32_16x16x32_bf16 v[50:53], a[72:75], v[26:29], v[50:53]
  v_mfma_f32_16x16x32_bf16 v[50:53], a[76:79], v[30:33], v[50:53]
  s_waitcnt vmcnt(4)
  buffer_load_dwordx4 a[0:3], v20, s[32:35], s65 offen offset:0 nt
  v_mfma_f32_16x16x32_bf16 v[42:45], a[36:39], v[12:15], v[42:45]
  v_mfma_f32_16x16x32_bf16 v[54:57], a[80:83], v[8:11], 0
  v_mfma_f32_16x16x32_bf16 v[54:57], a[84:87], v[12:15], v[54:57]
  v_mfma_f32_16x16x32_bf16 v[54:57], a[88:91], v[26:29], v[54:57]
  v_mfma_f32_16x16x32_bf16 v[54:57], a[92:95], v[30:33], v[54:57]
  s_nop 0
  v_mov_b32_dpp v25, v50 quad_perm:[0,0,0,0] row_mask:0xf bank_mask:0xf
  v_add_f32_dpp v25, v51, v25 quad_perm:[1,1,1,1] row_mask:0xf bank_mask:0xf
  v_add_f32_dpp v25, v52, v25 quad_perm:[2,2,2,2] row_mask:0xf bank_mask:0xf
  v_add_f32_dpp v25, v53, v25 quad_perm:[3,3,3,3] row_mask:0xf bank_mask:0xf
  v_max_f32 v24, v24, v25
  ds_write_b32 v22, v25 offset:0
  s_waitcnt vmcnt(4)
  buffer_load_dwordx4 a[4:7], v20, s[32:35], s65 offen offset:1024 nt
  v_mfma_f32_16x16x32_bf16 v[42:45], a[40:43], v[26:29], v[42:45]
  v_mfma_f32_16x16x32_bf16 v[50:53], a[96:99], v[8:11], 0
  v_mfma_f32_16x16x32_bf16 v[50:53], a[100:103], v[12:15], v[50:53]
  v_mfma_f32_16x16x32_bf16 v[50:53], a[104:107], v[26:29], v[50:53]
  v_mfma_f32_16x16x32_bf16 v[50:53], a[108:111], v[30:33], v[50:53]
  v_mov_b32_dpp v25, v54 quad_perm:[0,0,0,0] row_mask:0xf bank_mask:0xf
  v_add_f32_dpp v25, v55, v25 quad_perm:[1,1,1,1] row_mask:0xf bank_mask:0xf
  v_add_f32_dpp v25, v56, v25 quad_perm:[2,2,2,2] row_mask:0xf bank_mask:0xf
  v_add_f32_dpp v25, v57, v25 quad_perm:[3,3,3,3] row_mask:0xf bank_mask:0xf
  v_max_f32 v24, v24, v25
  ds_write_b32 v22, v25 offset:64
  s_waitcnt vmcnt(4)
  buffer_load_dwordx4 a[8:11], v20, s[32:35], s65 offen offset:2048 nt
  v_mfma_f32_16x16x32_bf16 v[42:45], a[44:47], v[30:33], v[42:45]
  v_mfma_f32_16x16x32_bf16 v[54:57], a[112:115], v[8:11], 0
  v_mfma_f32_16x16x32_bf16 v[54:57], a[116:119], v[12:15], v[54:57]
  v_mfma_f32_16x16x32_bf16 v[54:57], a[120:123], v[26:29], v[54:57]
  v_mfma_f32_16x16x32_bf16 v[54:57], a[124:127], v[30:33], v[54:57]
  v_mov_b32_dpp v25, v50 quad_perm:[0,0,0,0] row_mask:0xf bank_mask:0xf
  v_add_f32_dpp v25, v51, v25 quad_perm:[1,1,1,1] row_mask:0xf bank_mask:0xf
  v_add_f32_dpp v25, v52, v25 quad_perm:[2,2,2,2] row_mask:0xf bank_mask:0xf
  v_add_f32_dpp v25, v53, v25 quad_perm:[3,3,3,3] row_mask:0xf bank_mask:0xf
  v_max_f32 v24, v24, v25
  ds_write_b32 v22, v25 offset:128
  s_waitcnt vmcnt(4)
  buffer_load_dwordx4 a[12:15], v20, s[32:35], s65 offen offset:3072 nt
  s_add_u32 s65, s65, 32768
  v_mfma_f32_16x16x32_bf16 v[46:49], a[48:51], v[8:11], 0
  v_mov_b32_dpp v25, v42 quad_perm:[0,0,0,0] row_mask:0xf bank_mask:0xf
  v_add_f32_dpp v25, v43, v25 quad_perm:[1,1,1,1] row_mask:0xf bank_mask:0xf
  v_add_f32_dpp v25, v44, v25 quad_perm:[2,2,2,2] row_mask:0xf bank_mask:0xf
  v_add_f32_dpp v25, v45, v25 quad_perm:[3,3,3,3] row_mask:0xf bank_mask:0xf
  v_max_f32 v24, v24, v25
  ds_write_b32 v22, v25 offset:384
  v_mov_b32_dpp v25, v54 quad_perm:[0,0,0,0] row_mask:0xf bank_mask:0xf
  v_add_f32_dpp v25, v55, v25 quad_perm:[1,1,1,1] row_mask:0xf bank_mask:0xf
  v_add_f32_dpp v25, v56, v25 quad_perm:[2,2,2,2] row_mask:0xf bank_mask:0xf
  v_add_f32_dpp v25, v57, v25 quad_perm:[3,3,3,3] row_mask:0xf bank_mask:0xf
  v_max_f32 v24, v24, v25
  ds_write_b32 v22, v25 offset:192
  s_waitcnt vmcnt(4)
  buffer_load_dwordx4 a[16:19], v20, s[32:35], s65 offen offset:0 nt
  v_mfma_f32_16x16x32_bf16 v[46:49], a[52:55], v[12:15], v[46:49]
  s_waitcnt vmcnt(4)
  buffer_load_dwordx4 a[20:23], v20, s[32:35], s65 offen offset:1024 nt
  v_mfma_f32_16x16x32_bf16 v[46:49], a[56:59], v[26:29], v[46:49]
  s_waitcnt vmcnt(4)
  buffer_load_dwordx4 a[24:27], v20, s[32:35], s65 offen offset:2048 nt
  v_mfma_f32_16x16x32_bf16 v[46:49], a[60:63], v[30:33], v[46:49]
  s_waitcnt vmcnt(4)
  buffer_load_dwordx4 a[28:31], v20, s[32:35], s65 offen offset:3072 nt
  s_add_u32 s65, s65, 32768
  v_mfma_f32_16x16x32_bf16 v[42:45], a[0:3], v[8:11], 0
  s_nop 3
  v_mov_b32_dpp v25, v46 quad_perm:[0,0,0,0] row_mask:0xf bank_mask:0xf
  v_add_f32_dpp v25, v47, v25 quad_perm:[1,1,1,1] row_mask:0xf bank_mask:0xf
  v_add_f32_dpp v25, v48, v25 quad_perm:[2,2,2,2] row_mask:0xf bank_mask:0xf
  v_add_f32_dpp v25, v49, v25 quad_perm:[3,3,3,3] row_mask:0xf bank_mask:0xf
  v_max_f32 v24, v24, v25
  ds_write_b32 v22, v25 offset:448
  s_waitcnt vmcnt(4)
  buffer_load_dwordx4 a[32:35], v20, s[32:35], s65 offen offset:0 nt
  v_mfma_f32_16x16x32_bf16 v[42:45], a[4:7], v[12:15], v[42:45]
  s_waitcnt vmcnt(4)
  buffer_load_dwordx4 a[36:39], v20, s[32:35], s65 offen offset:1024 nt
  v_mfma_f32_16x16x32_bf16 v[42:45], a[8:11], v[26:29], v[42:45]
  s_waitcnt vmcnt(4)
  buffer_load_dwordx4 a[40:43], v20, s[32:35], s65 offen offset:2048 nt
  v_mfma_f32_16x16x32_bf16 v[42:45], a[12:15], v[30:33], v[42:45]
  s_waitcnt vmcnt(4)
  buffer_load_dwordx4 a[44:47], v20, s[32:35], s65 offen offset:3072 nt
  s_add_u32 s65, s65, 32768
  v_mfma_f32_16x16x32_bf16 v[46:49], a[16:19], v[8:11], 0
  s_nop 3
  v_mov_b32_dpp v25, v42 quad_perm:[0,0,0,0] row_mask:0xf bank_mask:0xf
  v_add_f32_dpp v25, v43, v25 quad_perm:[1,1,1,1] row_mask:0xf bank_mask:0xf
  v_add_f32_dpp v25, v44, v25 quad_perm:[2,2,2,2] row_mask:0xf bank_mask:0xf
  v_add_f32_dpp v25, v45, v25 quad_perm:[3,3,3,3] row_mask:0xf bank_mask:0xf
  v_max_f32 v24, v24, v25
  ds_write_b32 v22, v25 offset:512
  s_waitcnt vmcnt(4)
  buffer_load_dwordx4 a[48:51], v20, s[32:35], s65 offen offset:0 nt
  v_mfma_f32_16x16x32_bf16 v[46:49], a[20:23], v[12:15], v[46:49]
  s_waitcnt vmcnt(4)
  buffer_load_dwordx4 a[52:55], v20, s[32:35], s65 offen offset:1024 nt
  v_mfma_f32_16x16x32_bf16 v[46:49], a[24:27], v[26:29], v[46:49]
  s_waitcnt vmcnt(4)
  buffer_load_dwordx4 a[56:59], v20, s[32:35], s65 offen offset:2048 nt
  v_mfma_f32_16x16x32_bf16 v[46:49], a[28:31], v[30:33], v[46:49]
  s_waitcnt vmcnt(4)
  buffer_load_dwordx4 a[60:63], v20, s[32:35], s65 offen offset:3072 nt
  s_add_u32 s65, s65, 32768
  v_mfma_f32_16x16x32_bf16 v[42:45], a[32:35], v[8:11], 0
  s_nop 3
  v_mov_b32_dpp v25, v46 quad_perm:[0,0,0,0] row_mask:0xf bank_mask:0xf
  v_add_f32_dpp v25, v47, v25 quad_perm:[1,1,1,1] row_mask:0xf bank_mask:0xf
  v_add_f32_dpp v25, v48, v25 quad_perm:[2,2,2,2] row_mask:0xf bank_mask:0xf
  v_add_f32_dpp v25, v49, v25 quad_perm:[3,3,3,3] row_mask:0xf bank_mask:0xf
  v_max_f32 v24, v24, v25
  ds_write_b32 v22, v25 offset:576
  v_add_u32 v22, 576, v22
  s_lshl_b32 s60, s3, 2
  s_add_u32 s60, s60, 156224
  v_mov_b32 v90, s60
  v_mov_b32 v92, 156224
  s_mov_b32 s64, 0
  ds_read_b32 v91, v92 offset:16
L_ktop:
  s_waitcnt lgkmcnt(0)
  v_readfirstlane_b32 s60, v91
  v_mov_b32 v93, s64
  ds_write_b32 v90, v93
  s_add_u32 s64, s64, 1
  s_cmp_eq_u32 s60, 1
  s_cbranch_scc1 L_klv1
  s_cmp_eq_u32 s60, 2
  s_cbranch_scc1 L_klv2
L_klv0:
  s_waitcnt vmcnt(4)
  buffer_load_dwordx4 a[0:3], v20, s[32:35], s65 offen offset:0 nt
  v_mfma_f32_16x16x32_bf16 v[42:45], a[36:39], v[12:15], v[42:45]
  s_waitcnt vmcnt(4)
  buffer_load_dwordx4 a[4:7], v20, s[32:35], s65 offen offset:1024 nt
  v_mfma_f32_16x16x32_bf16 v[42:45], a[40:43], v[26:29], v[42:45]
  s_waitcnt vmcnt(4)
  buffer_load_dwordx4 a[8:11], v20, s[32:35], s65 offen offset:2048 nt
  v_mfma_f32_16x16x32_bf16 v[42:45], a[44:47], v[30:33], v[42:45]
  s_waitcnt vmcnt(4)
  buffer_load_dwordx4 a[12:15], v20, s[32:35], s65 offen offset:3072 nt
  s_add_u32 s65, s65, 32768
  v_mfma_f32_16x16x32_bf16 v[46:49], a[48:51], v[8:11], 0
  s_nop 3
  v_mov_b32_dpp v25, v42 quad_perm:[0,0,0,0] row_mask:0xf bank_mask:0xf
  v_add_f32_dpp v25, v43, v25 quad_perm:[1,1,1,1] row_mask:0xf bank_mask:0xf
  v_add_f32_dpp v25, v44, v25 quad_perm:[2,2,2,2] row_mask:0xf bank_mask:0xf
  v_add_f32_dpp v25, v45, v25 quad_perm:[3,3,3,3] row_mask:0xf bank_mask:0xf
  v_max_f32 v24, v24, v25
  ds_write_b32 v22, v25 offset:64
  s_waitcnt vmcnt(4)
  buffer_load_dwordx4 a[16:19], v20, s[32:35], s65 offen offset:0 nt
  v_mfma_f32_16x16x32_bf16 v[46:49], a[52:55], v[12:15], v[46:49]
  s_waitcnt vmcnt(4)
  buffer_load_dwordx4 a[20:23], v20, s[32:35], s65 offen offset:1024 nt
  v_mfma_f32_16x16x32_bf16 v[46:49], a[56:59], v[26:29], v[46:49]
  s_waitcnt vmcnt(4)
  buffer_load_dwordx4 a[24:27], v20, s[32:35], s65 offen offset:2048 nt
  v_mfma_f32_16x16x32_bf16 v[46:49], a[60:63], v[30:33], v[46:49]
  s_waitcnt vmcnt(4)
  buffer_load_dwordx4 a[28:31], v20, s[32:35], s65 offen offset:3072 nt
  s_add_u32 s65, s65, 32768
  v_mfma_f32_16x16x32_bf16 v[42:45], a[0:3], v[8:11], 0
  s_nop 3
  v_mov_b32_dpp v25, v46 quad_perm:[0,0,0,0] row_mask:0xf bank_mask:0xf
  v_add_f32_dpp v25, v47, v25 quad_perm:[1,1,1,1] row_mask:0xf bank_mask:0xf
  v_add_f32_dpp v25, v48, v25 quad_perm:[2,2,2,2] row_mask:0xf bank_mask:0xf
  v_add_f32_dpp v25, v49, v25 quad_perm:[3,3,3,3] row_mask:0xf bank_mask:0xf
  v_max_f32 v24, v24, v25
  ds_write_b32 v22, v25 offset:128
  s_waitcnt vmcnt(4)
  buffer_load_dwordx4 a[32:35], v20, s[32:35], s65 offen offset:0 nt
  v_mfma_f32_16x16x32_bf16 v[42:45], a[4:7], v[12:15], v[42:45]
  s_waitcnt vmcnt(4)
  buffer_load_dwordx4 a[36:39], v20, s[32:35], s65 offen offset:1024 nt
  v_mfma_f32_16x16x32_bf16 v[42:45], a[8:11], v[26:29], v[42:45]
  s_waitcnt vmcnt(4)
  buffer_load_dwordx4 a[40:43], v20, s[32:35], s65 offen offset:2048 nt
  v_mfma_f32_16x16x32_bf16 v[42:45], a[12:15], v[30:33], v[42:45]
  s_waitcnt vmcnt(4)
  buffer_load_dwordx4 a[44:47], v20, s[32:35], s65 offen offset:3072 nt
  s_add_u32 s65, s65, 32768
  v_mfma_f32_16x16x32_bf16 v[46:49], a[16:19], v[8:11], 0
  s_nop 3
  v_mov_b32_dpp v25, v42 quad_perm:[0,0,0,0] row_mask:0xf bank_mask:0xf
  v_add_f32_dpp v25, v43, v25 quad_perm:[1,1,1,1] row_mask:0xf bank_mask:0xf
  v_add_f32_dpp v25, v44, v25 quad_perm:[2,2,2,2] row_mask:0xf bank_mask:0xf
  v_add_f32_dpp v25, v45, v25 quad_perm:[3,3,3,3] row_mask:0xf bank_mask:0xf
  v_max_f32 v24, v24, v25
  ds_write_b32 v22, v25 offset:192
  s_waitcnt vmcnt(4)
  buffer_load_dwordx4 a[48:51], v20, s[32:35], s65 offen offset:0 nt
  v_mfma_f32_16x16x32_bf16 v[46:49], a[20:23], v[12:15], v[46:49]
  s_waitcnt vmcnt(4)
  buffer_load_dwordx4 a[52:55], v20, s[32:35], s65 offen offset:1024 nt
  v_mfma_f32_16x16x32_bf16 v[46:49], a[24:27], v[26:29], v[46:49]
  s_waitcnt vmcnt(4)
  buffer_load_dwordx4 a[56:59], v20, s[32:35], s65 offen offset:2048 nt
  v_mfma_f32_16x16x32_bf16 v[46:49], a[28:31], v[30:33], v[46:49]
  ds_read_b32 v91, v92 offset:16
  s_waitcnt vmcnt(4)
  buffer_load_dwordx4 a[60:63], v20, s[32:35], s65 offen offset:3072 nt
  s_add_u32 s65, s65, 32768
  v_mfma_f32_16x16x32_bf16 v[42:45], a[32:35], v[8:11], 0
  s_nop 2
  v_mov_b32_dpp v25, v46 quad_perm:[0,0,0,0] row_mask:0xf bank_mask:0xf
  v_add_f32_dpp v25, v47, v25 quad_perm:[1,1,1,1] row_mask:0xf bank_mask:0xf
  v_add_f32_dpp v25, v48, v25 quad_perm:[2,2,2,2] row_mask:0xf bank_mask:0xf
  v_add_f32_dpp v25, v49, v25 quad_perm:[3,3,3,3] row_mask:0xf bank_mask:0xf
  v_max_f32 v24, v24, v25
  ds_write_b32 v22, v25 offset:256
  v_add_u32 v22, 256, v22
  s_cmp_lt_u32 s64, 13
  s_cbranch_scc1 L_ktop
  s_branch L_kdone
L_klv1:
  s_waitcnt vmcnt(5)
  buffer_load_dwordx4 a[0:3], v20, s[32:35], s65 offen offset:0 nt
  v_mfma_f32_16x16x32_bf16 v[42:45], a[36:39], v[12:15], v[42:45]
  s_waitcnt vmcnt(5)
  buffer_load_dwordx4 a[4:7], v20, s[32:35], s65 offen offset:1024 nt
  v_mfma_f32_16x16x32_bf16 v[42:45], a[40:43], v[26:29], v[42:45]
  s_waitcnt vmcnt(5)
  buffer_load_dwordx4 a[8:11], v20, s[32:35], s65 offen offset:2048 nt
  v_mfma_f32_16x16x32_bf16 v[42:45], a[44:47], v[30:33], v[42:45]
  s_waitcnt vmcnt(5)
  buffer_load_dwordx4 a[12:15], v20, s[32:35], s65 offen offset:3072 nt
  s_add_u32 s65, s65, 32768
  v_mfma_f32_16x16x32_bf16 v[46:49], a[48:51], v[8:11], 0
  s_nop 3
  v_mov_b32_dpp v25, v42 quad_perm:[0,0,0,0] row_mask:0xf bank_mask:0xf
  v_add_f32_dpp v25, v43, v25 quad_perm:[1,1,1,1] row_mask:0xf bank_mask:0xf
  v_add_f32_dpp v25, v44, v25 quad_perm:[2,2,2,2] row_mask:0xf bank_mask:0xf
  v_add_f32_dpp v25, v45, v25 quad_perm:[3,3,3,3] row_mask:0xf bank_mask:0xf
  v_max_f32 v24, v24, v25
  ds_write_b32 v22, v25 offset:64
  s_waitcnt vmcnt(5)
  buffer_load_dwordx4 a[16:19], v20, s[32:35], s65 offen offset:0 nt
  v_mfma_f32_16x16x32_bf16 v[46:49], a[52:55], v[12:15], v[46:49]
  s_waitcnt vmcnt(5)
  buffer_load_dwordx4 a[20:23], v20, s[32:35], s65 offen offset:1024 nt
  v_mfma_f32_16x16x32_bf16 v[46:49], a[56:59], v[26:29], v[46:49]
  s_waitcnt vmcnt(5)
  buffer_load_dwordx4 a[24:27], v20, s[32:35], s65 offen offset:2048 nt
  v_mfma_f32_16x16x32_bf16 v[46:49], a[60:63], v[30:33], v[46:49]
  s_waitcnt vmcnt(5)
  buffer_load_dwordx4 a[28:31], v20, s[32:35], s65 offen offset:3072 nt
  s_add_u32 s65, s65, 32768
  v_mfma_f32_16x16x32_bf16 v[42:45], a[0:3], v[8:11], 0
  s_nop 3
  v_mov_b32_dpp v25, v46 quad_perm:[0,0,0,0] row_mask:0xf bank_mask:0xf
  v_add_f32_dpp v25, v47, v25 quad_perm:[1,1,1,1] row_mask:0xf bank_mask:0xf
  v_add_f32_dpp v25, v48, v25 quad_perm:[2,2,2,2] row_mask:0xf bank_mask:0xf
  v_add_f32_dpp v25, v49, v25 quad_perm:[3,3,3,3] row_mask:0xf bank_mask:0xf
  v_max_f32 v24, v24, v25
  ds_write_b32 v22, v25 offset:128
  s_waitcnt vmcnt(5)
  buffer_load_dwordx4 a[32:35], v20, s[32:35], s65 offen offset:0 nt
  v_mfma_f32_16x16x32_bf16 v[42:45], a[4:7], v[12:15], v[42:45]
  s_waitcnt vmcnt(5)
  buffer_load_dwordx4 a[36:39], v20, s[32:35], s65 offen offset:1024 nt
  v_mfma_f32_16x16x32_bf16 v[42:45], a[8:11], v[26:29], v[42:45]
  s_waitcnt vmcnt(5)
  buffer_load_dwordx4 a[40:43], v20, s[32:35], s65 offen offset:2048 nt
  v_mfma_f32_16x16x32_bf16 v[42:45], a[12:15], v[30:33], v[42:45]
  s_waitcnt vmcnt(5)
  buffer_load_dwordx4 a[44:47], v20, s[32:35], s65 offen offset:3072 nt
  s_add_u32 s65, s65, 32768
  v_mfma_f32_16x16x32_bf16 v[46:49], a[16:19], v[8:11], 0
  s_nop 3
  v_mov_b32_dpp v25, v42 quad_perm:[0,0,0,0] row_mask:0xf bank_mask:0xf
  v_add_f32_dpp v25, v43, v25 quad_perm:[1,1,1,1] row_mask:0xf bank_mask:0xf
  v_add_f32_dpp v25, v44, v25 quad_perm:[2,2,2,2] row_mask:0xf bank_mask:0xf
  v_add_f32_dpp v25, v45, v25 quad_perm:[3,3,3,3] row_mask:0xf bank_mask:0xf
  v_max_f32 v24, v24, v25
  ds_write_b32 v22, v25 offset:192
  s_waitcnt vmcnt(5)
  buffer_load_dwordx4 a[48:51], v20, s[32:35], s65 offen offset:0 nt
  v_mfma_f32_16x16x32_bf16 v[46:49], a[20:23], v[12:15], v[46:49]
  s_waitcnt vmcnt(5)
  buffer_load_dwordx4 a[52:55], v20, s[32:35], s65 offen offset:1024 nt
  v_mfma_f32_16x16x32_bf16 v[46:49], a[24:27], v[26:29], v[46:49]
  s_waitcnt vmcnt(5)
  buffer_load_dwordx4 a[56:59], v20, s[32:35], s65 offen offset:2048 nt
  v_mfma_f32_16x16x32_bf16 v[46:49], a[28:31], v[30:33], v[46:49]
  ds_read_b32 v91, v92 offset:16
  s_waitcnt vmcnt(5)
  buffer_load_dwordx4 a[60:63], v20, s[32:35], s65 offen offset:3072 nt
  s_add_u32 s65, s65, 32768
  v_mfma_f32_16x16x32_bf16 v[42:45], a[32:35], v[8:11], 0
  s_nop 2
  v_mov_b32_dpp v25, v46 quad_perm:[0,0,0,0] row_mask:0xf bank_mask:0xf
  v_add_f32_dpp v25, v47, v25 quad_perm:[1,1,1,1] row_mask:0xf bank_mask:0xf
  v_add_f32_dpp v25, v48, v25 quad_perm:[2,2,2,2] row_mask:0xf bank_mask:0xf
  v_add_f32_dpp v25, v49, v25 quad_perm:[3,3,3,3] row_mask:0xf bank_mask:0xf
  v_max_f32 v24, v24, v25
  ds_write_b32 v22, v25 offset:256
  v_add_u32 v22, 256, v22
  s_cmp_lt_u32 s64, 13
  s_cbranch_scc1 L_ktop
  s_branch L_kdone
L_klv2:
  s_waitcnt vmcnt(6)
  buffer_load_dwordx4 a[0:3], v20, s[32:35], s65 offen offset:0 nt
  v_mfma_f32_16x16x32_bf16 v[42:45], a[36:39], v[12:15], v[42:45]
  s_waitcnt vmcnt(6)
  buffer_load_dwordx4 a[4:7], v20, s[32:35], s65 offen offset:1024 nt
  v_mfma_f32_16x16x32_bf16 v[42:45], a[40:43], v[26:29], v[42:45]
  s_waitcnt vmcnt(6)
  buffer_load_dwordx4 a[8:11], v20, s[32:35], s65 offen offset:2048 nt
  v_mfma_f32_16x16x32_bf16 v[42:45], a[44:47], v[30:33], v[42:45]
  s_waitcnt vmcnt(6)
  buffer_load_dwordx4 a[12:15], v20, s[32:35], s65 offen offset:3072 nt
  s_add_u32 s65, s65, 32768
  v_mfma_f32_16x16x32_bf16 v[46:49], a[48:51], v[8:11], 0
  s_nop 3
  v_mov_b32_dpp v25, v42 quad_perm:[0,0,0,0] row_mask:0xf bank_mask:0xf
  v_add_f32_dpp v25, v43, v25 quad_perm:[1,1,1,1] row_mask:0xf bank_mask:0xf
  v_add_f32_dpp v25, v44, v25 quad_perm:[2,2,2,2] row_mask:0xf bank_mask:0xf
  v_add_f32_dpp v25, v45, v25 quad_perm:[3,3,3,3] row_mask:0xf bank_mask:0xf
  v_max_f32 v24, v24, v25
  ds_write_b32 v22, v25 offset:64
  s_waitcnt vmcnt(6)
  buffer_load_dwordx4 a[16:19], v20, s[32:35], s65 offen offset:0 nt
  v_mfma_f32_16x16x32_bf16 v[46:49], a[52:55], v[12:15], v[46:49]
  s_waitcnt vmcnt(6)
  buffer_load_dwordx4 a[20:23], v20, s[32:35], s65 offen offset:1024 nt
  v_mfma_f32_16x16x32_bf16 v[46:49], a[56:59], v[26:29], v[46:49]
  s_waitcnt vmcnt(6)
  buffer_load_dwordx4 a[24:27], v20, s[32:35], s65 offen offset:2048 nt
  v_mfma_f32_16x16x32_bf16 v[46:49], a[60:63], v[30:33], v[46:49]
  s_waitcnt vmcnt(6)
  buffer_load_dwordx4 a[28:31], v20, s[32:35], s65 offen offset:3072 nt
  s_add_u32 s65, s65, 32768
  v_mfma_f32_16x16x32_bf16 v[42:45], a[0:3], v[8:11], 0
  s_nop 3
  v_mov_b32_dpp v25, v46 quad_perm:[0,0,0,0] row_mask:0xf bank_mask:0xf
  v_add_f32_dpp v25, v47, v25 quad_perm:[1,1,1,1] row_mask:0xf bank_mask:0xf
  v_add_f32_dpp v25, v48, v25 quad_perm:[2,2,2,2] row_mask:0xf bank_mask:0xf
  v_add_f32_dpp v25, v49, v25 quad_perm:[3,3,3,3] row_mask:0xf bank_mask:0xf
  v_max_f32 v24, v24, v25
  ds_write_b32 v22, v25 offset:128
  s_waitcnt vmcnt(6)
  buffer_load_dwordx4 a[32:35], v20, s[32:35], s65 offen offset:0 nt
  v_mfma_f32_16x16x32_bf16 v[42:45], a[4:7], v[12:15], v[42:45]
  s_waitcnt vmcnt(6)
  buffer_load_dwordx4 a[36:39], v20, s[32:35], s65 offen offset:1024 nt
  v_mfma_f32_16x16x32_bf16 v[42:45], a[8:11], v[26:29], v[42:45]
  s_waitcnt vmcnt(6)
  buffer_load_dwordx4 a[40:43], v20, s[32:35], s65 offen offset:2048 nt
  v_mfma_f32_16x16x32_bf16 v[42:45], a[12:15], v[30:33], v[42:45]
  s_waitcnt vmcnt(6)
  buffer_load_dwordx4 a[44:47], v20, s[32:35], s65 offen offset:3072 nt
  s_add_u32 s65, s65, 32768
  v_mfma_f32_16x16x32_bf16 v[46:49], a[16:19], v[8:11], 0
  s_nop 3
  v_mov_b32_dpp v25, v42 quad_perm:[0,0,0,0] row_mask:0xf bank_mask:0xf
  v_add_f32_dpp v25, v43, v25 quad_perm:[1,1,1,1] row_mask:0xf bank_mask:0xf
  v_add_f32_dpp v25, v44, v25 quad_perm:[2,2,2,2] row_mask:0xf bank_mask:0xf
  v_add_f32_dpp v25, v45, v25 quad_perm:[3,3,3,3] row_mask:0xf bank_mask:0xf
  v_max_f32 v24, v24, v25
  ds_write_b32 v22, v25 offset:192
  s_waitcnt vmcnt(6)
  buffer_load_dwordx4 a[48:51], v20, s[32:35], s65 offen offset:0 nt
  v_mfma_f32_16x16x32_bf16 v[46:49], a[20:23], v[12:15], v[46:49]
  s_waitcnt vmcnt(6)
  buffer_load_dwordx4 a[52:55], v20, s[32:35], s65 offen offset:1024 nt
  v_mfma_f32_16x16x32_bf16 v[46:49], a[24:27], v[26:29], v[46:49]
  s_waitcnt vmcnt(6)
  buffer_load_dwordx4 a[56:59], v20, s[32:35], s65 offen offset:2048 nt
  v_mfma_f32_16x16x32_bf16 v[46:49], a[28:31], v[30:33], v[46:49]
  ds_read_b32 v91, v92 offset:16
  s_waitcnt vmcnt(6)
  buffer_load_dwordx4 a[60:63], v20, s[32:35], s65 offen offset:3072 nt
  s_add_u32 s65, s65, 32768
  v_mfma_f32_16x16x32_bf16 v[42:45], a[32:35], v[8:11], 0
  s_nop 2
  v_mov_b32_dpp v25, v46 quad_perm:[0,0,0,0] row_mask:0xf bank_mask:0xf
  v_add_f32_dpp v25, v47, v25 quad_perm:[1,1,1,1] row_mask:0xf bank_mask:0xf
  v_add_f32_dpp v25, v48, v25 quad_perm:[2,2,2,2] row_mask:0xf bank_mask:0xf
  v_add_f32_dpp v25, v49, v25 quad_perm:[3,3,3,3] row_mask:0xf bank_mask:0xf
  v_max_f32 v24, v24, v25
  ds_write_b32 v22, v25 offset:256
  v_add_u32 v22, 256, v22
  s_cmp_lt_u32 s64, 13
  s_cbranch_scc1 L_ktop
L_kdone:
  s_waitcnt vmcnt(4)
  buffer_load_dwordx4 a[0:3], v21, s[36:39], s66 offen offset:0 nt
  v_mfma_f32_16x16x32_bf16 v[42:45], a[36:39], v[12:15], v[42:45]
  s_waitcnt vmcnt(4)
  buffer_load_dwordx4 a[4:7], v21, s[36:39], s66 offen offset:128 nt
  v_mfma_f32_16x16x32_bf16 v[42:45], a[40:43], v[26:29], v[42:45]
  s_waitcnt vmcnt(4)
  buffer_load_dwordx4 a[8:11], v21, s[36:39], s66 offen offset:2048 nt
  v_mfma_f32_16x16x32_bf16 v[42:45], a[44:47], v[30:33], v[42:45]
  s_waitcnt vmcnt(4)
  buffer_load_dwordx4 a[12:15], v21, s[36:39], s66 offen offset:2176 nt
  s_add_u32 s66, s66, 32768
  v_mfma_f32_16x16x32_bf16 v[46:49], a[48:51], v[8:11], 0
  s_nop 3
  v_mov_b32_dpp v25, v42 quad_perm:[0,0,0,0] row_mask:0xf bank_mask:0xf
  v_add_f32_dpp v25, v43, v25 quad_perm:[1,1,1,1] row_mask:0xf bank_mask:0xf
  v_add_f32_dpp v25, v44, v25 quad_perm:[2,2,2,2] row_mask:0xf bank_mask:0xf
  v_add_f32_dpp v25, v45, v25 quad_perm:[3,3,3,3] row_mask:0xf bank_mask:0xf
  v_max_f32 v24, v24, v25
  ds_write_b32 v22, v25 offset:64
  s_waitcnt vmcnt(4)
  buffer_load_dwordx4 a[16:19], v21, s[36:39], s66 offen offset:0 nt
  v_mfma_f32_16x16x32_bf16 v[46:49], a[52:55], v[12:15], v[46:49]
  s_waitcnt vmcnt(4)
  buffer_load_dwordx4 a[20:23], v21, s[36:39], s66 offen offset:128 nt
  v_mfma_f32_16x16x32_bf16 v[46:49], a[56:59], v[26:29], v[46:49]
  s_waitcnt vmcnt(4)
  buffer_load_dwordx4 a[24:27], v21, s[36:39], s66 offen offset:2048 nt
  v_mfma_f32_16x16x32_bf16 v[46:49], a[60:63], v[30:33], v[46:49]
  s_waitcnt vmcnt(4)
  buffer_load_dwordx4 a[28:31], v21, s[36:39], s66 offen offset:2176 nt
  s_add_u32 s66, s66, 32768
  s_nop 4
  v_mov_b32_dpp v25, v46 quad_perm:[0,0,0,0] row_mask:0xf bank_mask:0xf
  v_add_f32_dpp v25, v47, v25 quad_perm:[1,1,1,1] row_mask:0xf bank_mask:0xf
  v_add_f32_dpp v25, v48, v25 quad_perm:[2,2,2,2] row_mask:0xf bank_mask:0xf
  v_add_f32_dpp v25, v49, v25 quad_perm:[3,3,3,3] row_mask:0xf bank_mask:0xf
  v_max_f32 v24, v24, v25
  ds_write_b32 v22, v25 offset:128
  ds_read_b128 v[64:67], v89 offset:0
  ds_read_b128 v[68:71], v89 offset:1024
  ds_read_b128 v[72:75], v89 offset:2048
  ds_read_b128 v[76:79], v89 offset:3072
  v_max_f32_dpp v24, v24, v24 row_ror:4 row_mask:0xf bank_mask:0xf
  s_nop 1
  v_max_f32_dpp v24, v24, v24 row_ror:8 row_mask:0xf bank_mask:0xf
  v_mov_b32 v25, v24
  s_nop 1
  v_permlane16_swap_b32 v25, v24
  v_max_f32 v24, v24, v25
  v_mov_b32 v25, v24
  s_nop 1
  v_permlane32_swap_b32 v25, v24
  v_max_f32 v24, v24, v25
  v_mul_f32 v24, s67, v24
  v_sub_f32 v80, 0, v24
  v_mov_b32 v50, 0
  v_mov_b32 v51, 0
  v_mov_b32 v52, 0
  v_mov_b32 v53, 0
  v_mov_b32 v54, 0
  v_mov_b32 v55, 0
  v_mov_b32 v56, 0
  v_mov_b32 v57, 0
  s_waitcnt vmcnt(4)
  buffer_load_dwordx4 a[32:35], v21, s[36:39], s66 offen offset:0 nt
  s_waitcnt lgkmcnt(0)
  v_fma_f32 v64, v64, s67, v80
  v_fma_f32 v65, v65, s67, v80
  v_fma_f32 v66, v66, s67, v80
  v_fma_f32 v67, v67, s67, v80
  v_exp_f32 v64, v64
  v_exp_f32 v65, v65
  v_exp_f32 v66, v66
  v_exp_f32 v67, v67
  v_add_f32 v5, v64, v65
  v_add_f32 v6, v66, v67
  v_add_f32 v5, v5, v6
  v_mov_b32 v81, v5
  v_cvt_pk_bf16_f32 v64, v64, v64
  v_cvt_pk_bf16_f32 v65, v65, v65
  v_cvt_pk_bf16_f32 v66, v66, v66
  v_cvt_pk_bf16_f32 v67, v67, v67
  ds_write_b128 v89, v[64:67] offset:0
  v_fma_f32 v68, v68, s67, v80
  v_fma_f32 v69, v69, s67, v80
  v_fma_f32 v70, v70, s67, v80
  v_fma_f32 v71, v71, s67, v80
  v_exp_f32 v68, v68
  v_exp_f32 v69, v69
  v_exp_f32 v70, v70
  v_exp_f32 v71, v71
  v_add_f32 v5, v68, v69
  v_add_f32 v6, v70, v71
  v_add_f32 v5, v5, v6
  v_add_f32 v81, v81, v5
  v_cvt_pk_bf16_f32 v68, v68, v68
  v_cvt_pk_bf16_f32 v69, v69, v69
  v_cvt_pk_bf16_f32 v70, v70, v70
  v_cvt_pk_bf16_f32 v71, v71, v71
  ds_write_b128 v89, v[68:71] offset:1024
  s_waitcnt vmcnt(4)
  buffer_load_dwordx4 a[36:39], v21, s[36:39], s66 offen offset:128 nt
  v_fma_f32 v72, v72, s67, v80
  v_fma_f32 v73, v73, s67, v80
  v_fma_f32 v74, v74, s67, v80
  v_fma_f32 v75, v75, s67, v80
  v_exp_f32 v72, v72
  v_exp_f32 v73, v73
  v_exp_f32 v74, v74
  v_exp_f32 v75, v75
  v_add_f32 v5, v72, v73
  v_add_f32 v6, v74, v75
  v_add_f32 v5, v5, v6
  v_add_f32 v81, v81, v5
  v_cvt_pk_bf16_f32 v72, v72, v72
  v_cvt_pk_bf16_f32 v73, v73, v73
  v_cvt_pk_bf16_f32 v74, v74, v74
  v_cvt_pk_bf16_f32 v75, v75, v75
  ds_write_b128 v89, v[72:75] offset:2048
  v_fma_f32 v76, v76, s67, v80
  v_fma_f32 v77, v77, s67, v80
  v_fma_f32 v78, v78, s67, v80
  v_fma_f32 v79, v79, s67, v80
  v_exp_f32 v76, v76
  v_exp_f32 v77, v77
  v_exp_f32 v78, v78
  v_exp_f32 v79, v79
  v_add_f32 v5, v76, v77
  v_add_f32 v6, v78, v79
  v_add_f32 v5, v5, v6
  v_add_f32 v81, v81, v5
  v_cvt_pk_bf16_f32 v76, v76, v76
  v_cvt_pk_bf16_f32 v77, v77, v77
  v_cvt_pk_bf16_f32 v78, v78, v78
  v_cvt_pk_bf16_f32 v79, v79, v79
  ds_write_b128 v89, v[76:79] offset:3072
  s_waitcnt vmcnt(4)
  buffer_load_dwordx4 a[40:43], v21, s[36:39], s66 offen offset:2048 nt
  ds_read2_b32 v[58:59], v23 offset0:0 offset1:8
  s_waitcnt vmcnt(4)
  buffer_load_dwordx4 a[44:47], v21, s[36:39], s66 offen offset:2176 nt
  s_add_u32 s66, s66, 32768
  s_waitcnt lgkmcnt(0)
  ds_read2_b32 v[60:61], v23 offset0:16 offset1:24
  v_and_b32 v34, v58, v16
  v_and_b32 v35, v58, v17
  v_and_b32 v36, v58, v18
  v_and_b32 v37, v58, v19
  s_nop 1
  v_mfma_f32_16x16x32_bf16 v[50:53], a[0:3], v[34:37], v[50:53]
  v_mfma_f32_16x16x32_bf16 v[54:57], a[4:7], v[34:37], v[54:57]
  v_and_b32 v38, v59, v16
  v_and_b32 v39, v59, v17
  v_and_b32 v40, v59, v18
  v_and_b32 v41, v59, v19
  s_nop 1
  v_mfma_f32_16x16x32_bf16 v[50:53], a[8:11], v[38:41], v[50:53]
  v_mfma_f32_16x16x32_bf16 v[54:57], a[12:15], v[38:41], v[54:57]
  s_waitcnt vmcnt(4)
  buffer_load_dwordx4 a[48:51], v21, s[36:39], s66 offen offset:0 nt
  s_waitcnt lgkmcnt(0)
  ds_read2_b32 v[58:59], v23 offset0:32 offset1:40
  v_and_b32 v34, v60, v16
  v_and_b32 v35, v60, v17
  v_and_b32 v36, v60, v18
  v_and_b32 v37, v60, v19
  s_nop 1
  v_mfma_f32_16x16x32_bf16 v[50:53], a[16:19], v[34:37], v[50:53]
  v_mfma_f32_16x16x32_bf16 v[54:57], a[20:23], v[34:37], v[54:57]
  s_waitcnt vmcnt(4)
  buffer_load_dwordx4 a[52:55], v21, s[36:39], s66 offen offset:128 nt
  v_and_b32 v38, v61, v16
  v_and_b32 v39, v61, v17
  v_and_b32 v40, v61, v18
  v_and_b32 v41, v61, v19
  s_nop 1
  v_mfma_f32_16x16x32_bf16 v[50:53], a[24:27], v[38:41], v[50:53]
  v_add_f32_dpp v81, v81, v81 row_ror:1 row_mask:0xf bank_mask:0xf
  s_nop 1
  v_add_f32_dpp v81, v81, v81 row_ror:2 row_mask:0xf bank_mask:0xf
  s_nop 1
  v_add_f32_dpp v81, v81, v81 row_ror:4 row_mask:0xf bank_mask:0xf
  s_nop 1
  v_add_f32_dpp v81, v81, v81 row_ror:8 row_mask:0xf bank_mask:0xf
  v_mov_b32 v25, v81
  s_nop 1
  v_permlane16_swap_b32 v25, v81
  v_add_f32 v81, v81, v25
  v_mov_b32 v25, v81
  s_nop 1
  v_permlane32_swap_b32 v25, v81
  v_add_f32 v81, v81, v25
  v_min_u32 v6, -2, v24
  v_min_u32 v7, -2, v81
  s_lshl_b32 s60, s3, 3
  s_add_u32 s60, s60, 156160
  v_mov_b32 v4, s60
  ds_write_b64 v4, v[6:7]
  s_waitcnt vmcnt(4)
  buffer_load_dwordx4 a[56:59], v21, s[36:39], s66 offen offset:2048 nt
  v_mfma_f32_16x16x32_bf16 v[54:57], a[28:31], v[38:41], v[54:57]
  s_lshl_b32 s60, s3, 11
  s_add_u32 s60, s60, 147456
  v_lshl_add_u32 v83, v1, 4, s60
  v_and_b32 v4, 1, v1
  v_mul_u32_u24 v4, 40, v4
  v_lshrrev_b32 v5, 3, v1
  v_add_u32 v4, v4, v5
  v_lshlrev_b32 v4, 4, v4
  v_bfe_u32 v6, v1, 1, 2
  v_lshl_add_u32 v4, v6, 11, v4
  s_lshr_b32 s60, s3, 1
  s_lshl_b32 s60, s60, 10
  s_and_b32 s61, s3, 1
  s_lshl_b32 s61, s61, 8
  s_add_u32 s60, s60, s61
  s_add_u32 s60, s60, 147456
  v_add_u32 v84, s60, v4
  v_lshlrev_b32 v85, 2, v6
  v_add_u32 v85, 156192, v85
  v_lshlrev_b32 v86, 3, v5
  s_waitcnt vmcnt(4)
  buffer_load_dwordx4 a[60:63], v21, s[36:39], s66 offen offset:2176 nt
  s_add_u32 s66, s66, 32768
  s_waitcnt lgkmcnt(0)
  ds_read2_b32 v[60:61], v23 offset0:48 offset1:56
  v_and_b32 v34, v58, v16
  v_and_b32 v35, v58, v17
  v_and_b32 v36, v58, v18
  v_and_b32 v37, v58, v19
  s_nop 1
  v_mfma_f32_16x16x32_bf16 v[50:53], a[32:35], v[34:37], v[50:53]
  s_mul_i32 s99, s2, 2944
  s_add_u32 s99, s99, 2097152
  s_lshl_b32 s60, s3, 6
  s_add_u32 s96, s99, s60
  s_lshl_b32 s60, s3, 9
  s_add_u32 s99, s99, s60
  s_and_b32 s61, s91, 15
  v_lshrrev_b32 v5, 2, v3
  v_and_b32 v6, 3, v3
  s_cmp_ge_u32 s2, 128
  s_cbranch_scc1 L_rpb_1
  v_lshl_add_u32 v4, v5, 6, v6
  s_lshl_b32 s60, s61, 2
  s_branch L_rpe_2
L_rpb_1:
  v_lshlrev_b32 v4, 3, v6
  v_and_b32 v6, 1, v5
  v_lshl_add_u32 v4, v6, 2, v4
  v_lshrrev_b32 v5, 1, v5
  v_lshl_add_u32 v4, v5, 7, v4
  s_and_b32 s60, s61, 3
  s_lshl_b32 s60, s60, 5
  s_lshr_b32 s61, s61, 2
  s_add_u32 s60, s60, s61
L_rpe_2:
  v_add_u32 v4, s60, v4
  v_mul_u32_u24 v87, 2944, v4
  v_lshl_add_u32 v87, v2, 4, v87
  s_lshr_b32 s97, s2, 7
  s_lshl_b32 s97, s97, 8
  s_add_u32 s97, s97, 2097536
  s_waitcnt vmcnt(4)
  buffer_load_dwordx4 a[0:3], v21, s[36:39], s66 offen offset:0 nt
  v_mfma_f32_16x16x32_bf16 v[54:57], a[36:39], v[34:37], v[54:57]
  v_lshrrev_b32 v4, 2, v3
  v_lshlrev_b32 v88, 7, v4
  v_lshl_add_u32 v88, v2, 5, v88
  v_and_b32 v4, 3, v3
  v_lshl_add_u32 v88, v4, 3, v88
  s_and_b32 s61, s2, 0x87
  s_mul_i32 s100, s61, 2944
  s_add_u32 s100, s100, 2098048
  s_and_b32 s61, s91, 15
  s_lshl_b32 s60, s61, 7
  s_add_u32 s100, s100, s60
  s_lshl_b32 s60, s3, 4
  s_add_u32 s100, s100, s60
  v_mul_u32_u24 v8, 23552, v3
  v_lshl_add_u32 v8, v2, 5, v8
  s_lshr_b32 s101, s2, 7
  s_lshl_b32 s101, s101, 3
  s_add_u32 s101, s101, s92
  s_lshl_b32 s101, s101, 8
  s_lshr_b32 s60, s61, 2
  s_lshl_b32 s60, s60, 6
  s_add_u32 s101, s101, s60
  s_and_b32 s60, s61, 3
  s_lshl_b32 s60, s60, 3
  s_add_u32 s101, s101, s60
  s_lshl_b32 s60, s3, 2
  s_add_u32 s101, s101, s60
  v_lshlrev_b32 v9, 12, v2
  v_lshl_add_u32 v9, v3, 5, v9
  s_mov_b32 s70, 0x1010101
  s_mov_b32 s71, 0x1010101
  s_mov_b32 s72, 0x20002
  s_mov_b32 s73, 0x20002
  s_mov_b32 s74, 0x30003
  s_mov_b32 s75, 0x30003
  s_waitcnt vmcnt(4)
  buffer_load_dwordx4 a[4:7], v21, s[36:39], s66 offen offset:128 nt
  v_and_b32 v38, v59, v16
  v_and_b32 v39, v59, v17
  v_and_b32 v40, v59, v18
  v_and_b32 v41, v59, v19
  s_nop 1
  v_mfma_f32_16x16x32_bf16 v[50:53], a[40:43], v[38:41], v[50:53]
  v_bfe_u32 v6, v3, 1, 1
  v_lshlrev_b32 v4, 7, v6
  v_lshrrev_b32 v5, 2, v3
  v_lshl_add_u32 v4, v5, 3, v4
  v_lshl_add_u32 v4, v2, 1, v4
  v_lshlrev_b32 v4, 8, v4
  v_lshl_add_u32 v5, v5, 2, v2
  v_lshlrev_b32 v6, 1, v6
  v_xor_b32 v5, v5, v6
  s_lshl_b32 s60, s3, 2
  v_xor_b32 v5, s60, v5
  v_lshl_add_u32 v4, v5, 4, v4
  v_and_b32 v5, 1, v3
  v_lshl_add_u32 v82, v5, 3, v4
  v_xor_b32 v26, 16, v82
  v_xor_b32 v27, 32, v82
  v_xor_b32 v28, 48, v82
  s_waitcnt vmcnt(4)
  buffer_load_dwordx4 a[8:11], v21, s[36:39], s66 offen offset:2048 nt
  v_mfma_f32_16x16x32_bf16 v[54:57], a[44:47], v[38:41], v[54:57]
  ds_read_b64_tr_b16 a[64:65], v82 offset:0
  ds_read_b64_tr_b16 a[66:67], v82 offset:256
  ds_read_b64_tr_b16 a[68:69], v26 offset:0
  ds_read_b64_tr_b16 a[70:71], v26 offset:256
  s_waitcnt vmcnt(4)
  buffer_load_dwordx4 a[12:15], v21, s[36:39], s66 offen offset:2176 nt
  s_add_u32 s66, s66, 32768
  s_waitcnt lgkmcnt(0)
  ds_read2_b32 v[58:59], v23 offset0:64 offset1:72
  v_and_b32 v34, v60, v16
  v_and_b32 v35, v60, v17
  v_and_b32 v36, v60, v18
  v_and_b32 v37, v60, v19
  s_nop 1
  v_mfma_f32_16x16x32_bf16 v[50:53], a[48:51], v[34:37], v[50:53]
  ds_read_b64_tr_b16 a[72:73], v27 offset:0
  ds_read_b64_tr_b16 a[74:75], v27 offset:256
  ds_read_b64_tr_b16 a[76:77], v28 offset:0
  ds_read_b64_tr_b16 a[78:79], v28 offset:256
  s_waitcnt vmcnt(4)
  buffer_load_dwordx4 a[16:19], v21, s[36:39], s66 offen offset:0 nt
  v_mfma_f32_16x16x32_bf16 v[54:57], a[52:55], v[34:37], v[54:57]
  ds_read_b64_tr_b16 a[80:81], v82 offset:8192
  ds_read_b64_tr_b16 a[82:83], v82 offset:8448
  ds_read_b64_tr_b16 a[84:85], v26 offset:8192
  ds_read_b64_tr_b16 a[86:87], v26 offset:8448
  s_waitcnt vmcnt(4)
  buffer_load_dwordx4 a[20:23], v21, s[36:39], s66 offen offset:128 nt
  v_and_b32 v38, v61, v16
  v_and_b32 v39, v61, v17
  v_and_b32 v40, v61, v18
  v_and_b32 v41, v61, v19
  s_nop 1
  v_mfma_f32_16x16x32_bf16 v[50:53], a[56:59], v[38:41], v[50:53]
  ds_read_b64_tr_b16 a[88:89], v27 offset:8192
  ds_read_b64_tr_b16 a[90:91], v27 offset:8448
  ds_read_b64_tr_b16 a[92:93], v28 offset:8192
  ds_read_b64_tr_b16 a[94:95], v28 offset:8448
  s_waitcnt vmcnt(4)
  buffer_load_dwordx4 a[24:27], v21, s[36:39], s66 offen offset:2048 nt
  v_mfma_f32_16x16x32_bf16 v[54:57], a[60:63], v[38:41], v[54:57]
  s_waitcnt vmcnt(4)
  buffer_load_dwordx4 a[28:31], v21, s[36:39], s66 offen offset:2176 nt
  s_add_u32 s66, s66, 32768
  s_waitcnt lgkmcnt(0)
  ds_read2_b32 v[60:61], v23 offset0:80 offset1:88
  v_and_b32 v34, v58, v16
  v_and_b32 v35, v58, v17
  v_and_b32 v36, v58, v18
  v_and_b32 v37, v58, v19
  s_nop 1
  v_mfma_f32_16x16x32_bf16 v[50:53], a[0:3], v[34:37], v[50:53]
  s_waitcnt vmcnt(4)
  buffer_load_dwordx4 a[32:35], v21, s[36:39], s66 offen offset:0 nt
  v_mfma_f32_16x16x32_bf16 v[54:57], a[4:7], v[34:37], v[54:57]
  s_waitcnt vmcnt(4)
  buffer_load_dwordx4 a[36:39], v21, s[36:39], s66 offen offset:128 nt
  v_and_b32 v38, v59, v16
  v_and_b32 v39, v59, v17
  v_and_b32 v40, v59, v18
  v_and_b32 v41, v59, v19
  s_nop 1
  v_mfma_f32_16x16x32_bf16 v[50:53], a[8:11], v[38:41], v[50:53]
  s_waitcnt vmcnt(4)
  buffer_load_dwordx4 a[40:43], v21, s[36:39], s66 offen offset:2048 nt
  v_mfma_f32_16x16x32_bf16 v[54:57], a[12:15], v[38:41], v[54:57]
  s_waitcnt vmcnt(4)
  buffer_load_dwordx4 a[44:47], v21, s[36:39], s66 offen offset:2176 nt
  s_add_u32 s66, s66, 32768
  s_waitcnt lgkmcnt(0)
  ds_read2_b32 v[58:59], v23 offset0:96 offset1:104
  v_and_b32 v34, v60, v16
  v_and_b32 v35, v60, v17
  v_and_b32 v36, v60, v18
  v_and_b32 v37, v60, v19
  s_nop 1
  v_mfma_f32_16x16x32_bf16 v[50:53], a[16:19], v[34:37], v[50:53]
  s_waitcnt vmcnt(4)
  buffer_load_dwordx4 a[48:51], v21, s[36:39], s66 offen offset:0 nt
  v_mfma_f32_16x16x32_bf16 v[54:57], a[20:23], v[34:37], v[54:57]
  s_waitcnt vmcnt(4)
  buffer_load_dwordx4 a[52:55], v21, s[36:39], s66 offen offset:128 nt
  v_and_b32 v38, v61, v16
  v_and_b32 v39, v61, v17
  v_and_b32 v40, v61, v18
  v_and_b32 v41, v61, v19
  s_nop 1
  v_mfma_f32_16x16x32_bf16 v[50:53], a[24:27], v[38:41], v[50:53]
  s_waitcnt vmcnt(4)
  buffer_load_dwordx4 a[56:59], v21, s[36:39], s66 offen offset:2048 nt
  v_mfma_f32_16x16x32_bf16 v[54:57], a[28:31], v[38:41], v[54:57]
  s_waitcnt vmcnt(4)
  buffer_load_dwordx4 a[60:63], v21, s[36:39], s66 offen offset:2176 nt
  s_add_u32 s66, s66, 32768
  s_waitcnt lgkmcnt(0)
  ds_read2_b32 v[60:61], v23 offset0:112 offset1:120
  v_and_b32 v34, v58, v16
  v_and_b32 v35, v58, v17
  v_and_b32 v36, v58, v18
  v_and_b32 v37, v58, v19
  s_nop 1
  v_mfma_f32_16x16x32_bf16 v[50:53], a[32:35], v[34:37], v[50:53]
  v_add_u32 v23, 256, v23
  ds_read_b32 v91, v92 offset:16
L_vtop:
  s_waitcnt lgkmcnt(0)
  v_readfirstlane_b32 s60, v91
  v_mov_b32 v93, s64
  ds_write_b32 v90, v93
  s_add_u32 s64, s64, 1
  s_cmp_eq_u32 s60, 1
  s_cbranch_scc1 L_vlv1
  s_cmp_eq_u32 s60, 2
  s_cbranch_scc1 L_vlv2
L_vlv0:
  s_waitcnt vmcnt(4)
  buffer_load_dwordx4 a[0:3], v21, s[36:39], s66 offen offset:0 nt
  v_mfma_f32_16x16x32_bf16 v[54:57], a[36:39], v[34:37], v[54:57]
  s_waitcnt vmcnt(4)
  buffer_load_dwordx4 a[4:7], v21, s[36:39], s66 offen offset:128 nt
  v_and_b32 v38, v59, v16
  v_and_b32 v39, v59, v17
  v_and_b32 v40, v59, v18
  v_and_b32 v41, v59, v19
  s_nop 1
  v_mfma_f32_16x16x32_bf16 v[50:53], a[40:43], v[38:41], v[50:53]
  s_waitcnt vmcnt(4)
  buffer_load_dwordx4 a[8:11], v21, s[36:39], s66 offen offset:2048 nt
  v_mfma_f32_16x16x32_bf16 v[54:57], a[44:47], v[38:41], v[54:57]
  s_waitcnt vmcnt(4)
  buffer_load_dwordx4 a[12:15], v21, s[36:39], s66 offen offset:2176 nt
  s_add_u32 s66, s66, 32768
  s_waitcnt lgkmcnt(0)
  ds_read2_b32 v[58:59], v23 offset0:64 offset1:72
  v_and_b32 v34, v60, v16
  v_and_b32 v35, v60, v17
  v_and_b32 v36, v60, v18
  v_and_b32 v37, v60, v19
  s_nop 1
  v_mfma_f32_16x16x32_bf16 v[50:53], a[48:51], v[34:37], v[50:53]
  s_waitcnt vmcnt(4)
  buffer_load_dwordx4 a[16:19], v21, s[36:39], s66 offen offset:0 nt
  v_mfma_f32_16x16x32_bf16 v[54:57], a[52:55], v[34:37], v[54:57]
  s_waitcnt vmcnt(4)
  buffer_load_dwordx4 a[20:23], v21, s[36:39], s66 offen offset:128 nt
  v_and_b32 v38, v61, v16
  v_and_b32 v39, v61, v17
  v_and_b32 v40, v61, v18
  v_and_b32 v41, v61, v19
  s_nop 1
  v_mfma_f32_16x16x32_bf16 v[50:53], a[56:59], v[38:41], v[50:53]
  s_waitcnt vmcnt(4)
  buffer_load_dwordx4 a[24:27], v21, s[36:39], s66 offen offset:2048 nt
  v_mfma_f32_16x16x32_bf16 v[54:57], a[60:63], v[38:41], v[54:57]
  s_waitcnt vmcnt(4)
  buffer_load_dwordx4 a[28:31], v21, s[36:39], s66 offen offset:2176 nt
  s_add_u32 s66, s66, 32768
  s_waitcnt lgkmcnt(0)
  ds_read2_b32 v[60:61], v23 offset0:80 offset1:88
  v_and_b32 v34, v58, v16
  v_and_b32 v35, v58, v17
  v_and_b32 v36, v58, v18
  v_and_b32 v37, v58, v19
  s_nop 1
  v_mfma_f32_16x16x32_bf16 v[50:53], a[0:3], v[34:37], v[50:53]
  s_waitcnt vmcnt(4)
  buffer_load_dwordx4 a[32:35], v21, s[36:39], s66 offen offset:0 nt
  v_mfma_f32_16x16x32_bf16 v[54:57], a[4:7], v[34:37], v[54:57]
  s_waitcnt vmcnt(4)
  buffer_load_dwordx4 a[36:39], v21, s[36:39], s66 offen offset:128 nt
  v_and_b32 v38, v59, v16
  v_and_b32 v39, v59, v17
  v_and_b32 v40, v59, v18
  v_and_b32 v41, v59, v19
  s_nop 1
  v_mfma_f32_16x16x32_bf16 v[50:53], a[8:11], v[38:41], v[50:53]
  s_waitcnt vmcnt(4)
  buffer_load_dwordx4 a[40:43], v21, s[36:39], s66 offen offset:2048 nt
  v_mfma_f32_16x16x32_bf16 v[54:57], a[12:15], v[38:41], v[54:57]
  s_waitcnt vmcnt(4)
  buffer_load_dwordx4 a[44:47], v21, s[36:39], s66 offen offset:2176 nt
  s_add_u32 s66, s66, 32768
  s_waitcnt lgkmcnt(0)
  ds_read2_b32 v[58:59], v23 offset0:96 offset1:104
  v_and_b32 v34, v60, v16
  v_and_b32 v35, v60, v17
  v_and_b32 v36, v60, v18
  v_and_b32 v37, v60, v19
  s_nop 1
  v_mfma_f32_16x16x32_bf16 v[50:53], a[16:19], v[34:37], v[50:53]
  s_waitcnt vmcnt(4)
  buffer_load_dwordx4 a[48:51], v21, s[36:39], s66 offen offset:0 nt
  v_mfma_f32_16x16x32_bf16 v[54:57], a[20:23], v[34:37], v[54:57]
  s_waitcnt vmcnt(4)
  buffer_load_dwordx4 a[52:55], v21, s[36:39], s66 offen offset:128 nt
  v_and_b32 v38, v61, v16
  v_and_b32 v39, v61, v17
  v_and_b32 v40, v61, v18
  v_and_b32 v41, v61, v19
  s_nop 1
  v_mfma_f32_16x16x32_bf16 v[50:53], a[24:27], v[38:41], v[50:53]
  s_waitcnt vmcnt(4)
  buffer_load_dwordx4 a[56:59], v21, s[36:39], s66 offen offset:2048 nt
  v_mfma_f32_16x16x32_bf16 v[54:57], a[28:31], v[38:41], v[54:57]
  ds_read_b32 v91, v92 offset:16
  s_waitcnt vmcnt(4)
  buffer_load_dwordx4 a[60:63], v21, s[36:39], s66 offen offset:2176 nt
  s_add_u32 s66, s66, 32768
  s_waitcnt lgkmcnt(0)
  ds_read2_b32 v[60:61], v23 offset0:112 offset1:120
  v_and_b32 v34, v58, v16
  v_and_b32 v35, v58, v17
  v_and_b32 v36, v58, v18
  v_and_b32 v37, v58, v19
  s_nop 1
  v_mfma_f32_16x16x32_bf16 v[50:53], a[32:35], v[34:37], v[50:53]
  v_add_u32 v23, 256, v23
  s_cmp_lt_u32 s64, 27
  s_cbranch_scc1 L_vtop
  s_branch L_vdone
L_vlv1:
  s_waitcnt vmcnt(5)
  buffer_load_dwordx4 a[0:3], v21, s[36:39], s66 offen offset:0 nt
  v_mfma_f32_16x16x32_bf16 v[54:57], a[36:39], v[34:37], v[54:57]
  s_waitcnt vmcnt(5)
  buffer_load_dwordx4 a[4:7], v21, s[36:39], s66 offen offset:128 nt
  v_and_b32 v38, v59, v16
  v_and_b32 v39, v59, v17
  v_and_b32 v40, v59, v18
  v_and_b32 v41, v59, v19
  s_nop 1
  v_mfma_f32_16x16x32_bf16 v[50:53], a[40:43], v[38:41], v[50:53]
  s_waitcnt vmcnt(5)
  buffer_load_dwordx4 a[8:11], v21, s[36:39], s66 offen offset:2048 nt
  v_mfma_f32_16x16x32_bf16 v[54:57], a[44:47], v[38:41], v[54:57]
  s_waitcnt vmcnt(5)
  buffer_load_dwordx4 a[12:15], v21, s[36:39], s66 offen offset:2176 nt
  s_add_u32 s66, s66, 32768
  s_waitcnt lgkmcnt(0)
  ds_read2_b32 v[58:59], v23 offset0:64 offset1:72
  v_and_b32 v34, v60, v16
  v_and_b32 v35, v60, v17
  v_and_b32 v36, v60, v18
  v_and_b32 v37, v60, v19
  s_nop 1
  v_mfma_f32_16x16x32_bf16 v[50:53], a[48:51], v[34:37], v[50:53]
  s_waitcnt vmcnt(5)
  buffer_load_dwordx4 a[16:19], v21, s[36:39], s66 offen offset:0 nt
  v_mfma_f32_16x16x32_bf16 v[54:57], a[52:55], v[34:37], v[54:57]
  s_waitcnt vmcnt(5)
  buffer_load_dwordx4 a[20:23], v21, s[36:39], s66 offen offset:128 nt
  v_and_b32 v38, v61, v16
  v_and_b32 v39, v61, v17
  v_and_b32 v40, v61, v18
  v_and_b32 v41, v61, v19
  s_nop 1
  v_mfma_f32_16x16x32_bf16 v[50:53], a[56:59], v[38:41], v[50:53]
  s_waitcnt vmcnt(5)
  buffer_load_dwordx4 a[24:27], v21, s[36:39], s66 offen offset:2048 nt
  v_mfma_f32_16x16x32_bf16 v[54:57], a[60:63], v[38:41], v[54:57]
  s_waitcnt vmcnt(5)
  buffer_load_dwordx4 a[28:31], v21, s[36:39], s66 offen offset:2176 nt
  s_add_u32 s66, s66, 32768
  s_waitcnt lgkmcnt(0)
  ds_read2_b32 v[60:61], v23 offset0:80 offset1:88
  v_and_b32 v34, v58, v16
  v_and_b32 v35, v58, v17
  v_and_b32 v36, v58, v18
  v_and_b32 v37, v58, v19
  s_nop 1
  v_mfma_f32_16x16x32_bf16 v[50:53], a[0:3], v[34:37], v[50:53]
  s_waitcnt vmcnt(5)
  buffer_load_dwordx4 a[32:35], v21, s[36:39], s66 offen offset:0 nt
  v_mfma_f32_16x16x32_bf16 v[54:57], a[4:7], v[34:37], v[54:57]
  s_waitcnt vmcnt(5)
  buffer_load_dwordx4 a[36:39], v21, s[36:39], s66 offen offset:128 nt
  v_and_b32 v38, v59, v16
  v_and_b32 v39, v59, v17
  v_and_b32 v40, v59, v18
  v_and_b32 v41, v59, v19
  s_nop 1
  v_mfma_f32_16x16x32_bf16 v[50:53], a[8:11], v[38:41], v[50:53]
  s_waitcnt vmcnt(5)
  buffer_load_dwordx4 a[40:43], v21, s[36:39], s66 offen offset:2048 nt
  v_mfma_f32_16x16x32_bf16 v[54:57], a[12:15], v[38:41], v[54:57]
  s_waitcnt vmcnt(5)
  buffer_load_dwordx4 a[44:47], v21, s[36:39], s66 offen offset:2176 nt
  s_add_u32 s66, s66, 32768
  s_waitcnt lgkmcnt(0)
  ds_read2_b32 v[58:59], v23 offset0:96 offset1:104
  v_and_b32 v34, v60, v16
  v_and_b32 v35, v60, v17
  v_and_b32 v36, v60, v18
  v_and_b32 v37, v60, v19
  s_nop 1
  v_mfma_f32_16x16x32_bf16 v[50:53], a[16:19], v[34:37], v[50:53]
  s_waitcnt vmcnt(5)
  buffer_load_dwordx4 a[48:51], v21, s[36:39], s66 offen offset:0 nt
  v_mfma_f32_16x16x32_bf16 v[54:57], a[20:23], v[34:37], v[54:57]
  s_waitcnt vmcnt(5)
  buffer_load_dwordx4 a[52:55], v21, s[36:39], s66 offen offset:128 nt
  v_and_b32 v38, v61, v16
  v_and_b32 v39, v61, v17
  v_and_b32 v40, v61, v18
  v_and_b32 v41, v61, v19
  s_nop 1
  v_mfma_f32_16x16x32_bf16 v[50:53], a[24:27], v[38:41], v[50:53]
  s_waitcnt vmcnt(5)
  buffer_load_dwordx4 a[56:59], v21, s[36:39], s66 offen offset:2048 nt
  v_mfma_f32_16x16x32_bf16 v[54:57], a[28:31], v[38:41], v[54:57]
  ds_read_b32 v91, v92 offset:16
  s_waitcnt vmcnt(5)
  buffer_load_dwordx4 a[60:63], v21, s[36:39], s66 offen offset:2176 nt
  s_add_u32 s66, s66, 32768
  s_waitcnt lgkmcnt(0)
  ds_read2_b32 v[60:61], v23 offset0:112 offset1:120
  v_and_b32 v34, v58, v16
  v_and_b32 v35, v58, v17
  v_and_b32 v36, v58, v18
  v_and_b32 v37, v58, v19
  s_nop 1
  v_mfma_f32_16x16x32_bf16 v[50:53], a[32:35], v[34:37], v[50:53]
  v_add_u32 v23, 256, v23
  s_cmp_lt_u32 s64, 27
  s_cbranch_scc1 L_vtop
  s_branch L_vdone
L_vlv2:
  s_waitcnt vmcnt(6)
  buffer_load_dwordx4 a[0:3], v21, s[36:39], s66 offen offset:0 nt
  v_mfma_f32_16x16x32_bf16 v[54:57], a[36:39], v[34:37], v[54:57]
  s_waitcnt vmcnt(6)
  buffer_load_dwordx4 a[4:7], v21, s[36:39], s66 offen offset:128 nt
  v_and_b32 v38, v59, v16
  v_and_b32 v39, v59, v17
  v_and_b32 v40, v59, v18
  v_and_b32 v41, v59, v19
  s_nop 1
  v_mfma_f32_16x16x32_bf16 v[50:53], a[40:43], v[38:41], v[50:53]
  s_waitcnt vmcnt(6)
  buffer_load_dwordx4 a[8:11], v21, s[36:39], s66 offen offset:2048 nt
  v_mfma_f32_16x16x32_bf16 v[54:57], a[44:47], v[38:41], v[54:57]
  s_waitcnt vmcnt(6)
  buffer_load_dwordx4 a[12:15], v21, s[36:39], s66 offen offset:2176 nt
  s_add_u32 s66, s66, 32768
  s_waitcnt lgkmcnt(0)
  ds_read2_b32 v[58:59], v23 offset0:64 offset1:72
  v_and_b32 v34, v60, v16
  v_and_b32 v35, v60, v17
  v_and_b32 v36, v60, v18
  v_and_b32 v37, v60, v19
  s_nop 1
  v_mfma_f32_16x16x32_bf16 v[50:53], a[48:51], v[34:37], v[50:53]
  s_waitcnt vmcnt(6)
  buffer_load_dwordx4 a[16:19], v21, s[36:39], s66 offen offset:0 nt
  v_mfma_f32_16x16x32_bf16 v[54:57], a[52:55], v[34:37], v[54:57]
  s_waitcnt vmcnt(6)
  buffer_load_dwordx4 a[20:23], v21, s[36:39], s66 offen offset:128 nt
  v_and_b32 v38, v61, v16
  v_and_b32 v39, v61, v17
  v_and_b32 v40, v61, v18
  v_and_b32 v41, v61, v19
  s_nop 1
  v_mfma_f32_16x16x32_bf16 v[50:53], a[56:59], v[38:41], v[50:53]
  s_waitcnt vmcnt(6)
  buffer_load_dwordx4 a[24:27], v21, s[36:39], s66 offen offset:2048 nt
  v_mfma_f32_16x16x32_bf16 v[54:57], a[60:63], v[38:41], v[54:57]
  s_waitcnt vmcnt(6)
  buffer_load_dwordx4 a[28:31], v21, s[36:39], s66 offen offset:2176 nt
  s_add_u32 s66, s66, 32768
  s_waitcnt lgkmcnt(0)
  ds_read2_b32 v[60:61], v23 offset0:80 offset1:88
  v_and_b32 v34, v58, v16
  v_and_b32 v35, v58, v17
  v_and_b32 v36, v58, v18
  v_and_b32 v37, v58, v19
  s_nop 1
  v_mfma_f32_16x16x32_bf16 v[50:53], a[0:3], v[34:37], v[50:53]
  s_waitcnt vmcnt(6)
  buffer_load_dwordx4 a[32:35], v21, s[36:39], s66 offen offset:0 nt
  v_mfma_f32_16x16x32_bf16 v[54:57], a[4:7], v[34:37], v[54:57]
  s_waitcnt vmcnt(6)
  buffer_load_dwordx4 a[36:39], v21, s[36:39], s66 offen offset:128 nt
  v_and_b32 v38, v59, v16
  v_and_b32 v39, v59, v17
  v_and_b32 v40, v59, v18
  v_and_b32 v41, v59, v19
  s_nop 1
  v_mfma_f32_16x16x32_bf16 v[50:53], a[8:11], v[38:41], v[50:53]
  s_waitcnt vmcnt(6)
  buffer_load_dwordx4 a[40:43], v21, s[36:39], s66 offen offset:2048 nt
  v_mfma_f32_16x16x32_bf16 v[54:57], a[12:15], v[38:41], v[54:57]
  s_waitcnt vmcnt(6)
  buffer_load_dwordx4 a[44:47], v21, s[36:39], s66 offen offset:2176 nt
  s_add_u32 s66, s66, 32768
  s_waitcnt lgkmcnt(0)
  ds_read2_b32 v[58:59], v23 offset0:96 offset1:104
  v_and_b32 v34, v60, v16
  v_and_b32 v35, v60, v17
  v_and_b32 v36, v60, v18
  v_and_b32 v37, v60, v19
  s_nop 1
  v_mfma_f32_16x16x32_bf16 v[50:53], a[16:19], v[34:37], v[50:53]
  s_waitcnt vmcnt(6)
  buffer_load_dwordx4 a[48:51], v21, s[36:39], s66 offen offset:0 nt
  v_mfma_f32_16x16x32_bf16 v[54:57], a[20:23], v[34:37], v[54:57]
  s_waitcnt vmcnt(6)
  buffer_load_dwordx4 a[52:55], v21, s[36:39], s66 offen offset:128 nt
  v_and_b32 v38, v61, v16
  v_and_b32 v39, v61, v17
  v_and_b32 v40, v61, v18
  v_and_b32 v41, v61, v19
  s_nop 1
  v_mfma_f32_16x16x32_bf16 v[50:53], a[24:27], v[38:41], v[50:53]
  s_waitcnt vmcnt(6)
  buffer_load_dwordx4 a[56:59], v21, s[36:39], s66 offen offset:2048 nt
  v_mfma_f32_16x16x32_bf16 v[54:57], a[28:31], v[38:41], v[54:57]
  ds_read_b32 v91, v92 offset:16
  s_waitcnt vmcnt(6)
  buffer_load_dwordx4 a[60:63], v21, s[36:39], s66 offen offset:2176 nt
  s_add_u32 s66, s66, 32768
  s_waitcnt lgkmcnt(0)
  ds_read2_b32 v[60:61], v23 offset0:112 offset1:120
  v_and_b32 v34, v58, v16
  v_and_b32 v35, v58, v17
  v_and_b32 v36, v58, v18
  v_and_b32 v37, v58, v19
  s_nop 1
  v_mfma_f32_16x16x32_bf16 v[50:53], a[32:35], v[34:37], v[50:53]
  v_add_u32 v23, 256, v23
  s_cmp_lt_u32 s64, 27
  s_cbranch_scc1 L_vtop
L_vdone:
  s_add_u32 m0, s7, 16384
  s_add_u32 s63, s6, 131072
  s_waitcnt vmcnt(6)
  buffer_load_dwordx4 v98, s[56:59], s63 offen nt lds
  v_mfma_f32_16x16x32_bf16 v[54:57], a[36:39], v[34:37], v[54:57]
  s_add_u32 m0, s7, 20480
  s_add_u32 s63, s6, 163840
  v_xor_b32 v99, 128, v98
  s_waitcnt vmcnt(6)
  buffer_load_dwordx4 v99, s[56:59], s63 offen nt lds
  v_and_b32 v38, v59, v16
  v_and_b32 v39, v59, v17
  v_and_b32 v40, v59, v18
  v_and_b32 v41, v59, v19
  s_nop 1
  v_mfma_f32_16x16x32_bf16 v[50:53], a[40:43], v[38:41], v[50:53]
  s_add_u32 m0, s7, 24576
  s_add_u32 s63, s6, 196608
  s_waitcnt vmcnt(6)
  buffer_load_dwordx4 v98, s[56:59], s63 offen nt lds
  v_mfma_f32_16x16x32_bf16 v[54:57], a[44:47], v[38:41], v[54:57]
  s_add_u32 m0, s7, 28672
  s_add_u32 s63, s6, 229376
  v_xor_b32 v99, 128, v98
  s_waitcnt vmcnt(6)
  buffer_load_dwordx4 v99, s[56:59], s63 offen nt lds
  s_waitcnt lgkmcnt(0)
  ds_read2_b32 v[58:59], v23 offset0:64 offset1:72
  v_and_b32 v34, v60, v16
  v_and_b32 v35, v60, v17
  v_and_b32 v36, v60, v18
  v_and_b32 v37, v60, v19
  s_nop 1
  v_mfma_f32_16x16x32_bf16 v[50:53], a[48:51], v[34:37], v[50:53]
  s_add_u32 m0, s7, 49152
  s_add_u32 s63, s6, 393216
  v_xor_b32 v99, 32, v98
  s_waitcnt vmcnt(6)
  buffer_load_dwordx4 v99, s[56:59], s63 offen nt lds
  v_mfma_f32_16x16x32_bf16 v[54:57], a[52:55], v[34:37], v[54:57]
  s_add_u32 m0, s7, 53248
  s_add_u32 s63, s6, 425984
  v_xor_b32 v99, 160, v98
  s_waitcnt vmcnt(6)
  buffer_load_dwordx4 v99, s[56:59], s63 offen nt lds
  v_and_b32 v38, v61, v16
  v_and_b32 v39, v61, v17
  v_and_b32 v40, v61, v18
  v_and_b32 v41, v61, v19
  s_nop 1
  v_mfma_f32_16x16x32_bf16 v[50:53], a[56:59], v[38:41], v[50:53]
  s_add_u32 m0, s7, 57344
  s_add_u32 s63, s6, 458752
  v_xor_b32 v99, 32, v98
  s_waitcnt vmcnt(6)
  buffer_load_dwordx4 v99, s[56:59], s63 offen nt lds
  v_mfma_f32_16x16x32_bf16 v[54:57], a[60:63], v[38:41], v[54:57]
  s_add_u32 m0, s7, 61440
  s_add_u32 s63, s6, 491520
  v_xor_b32 v99, 160, v98
  buffer_load_dwordx4 v99, s[56:59], s63 offen nt lds
  ds_write_b128 v83, v[50:53]
  s_nop 2
  ds_write_b128 v83, v[54:57] offset:1024
  s_mov_b32 s68, 65536
  s_waitcnt lgkmcnt(0)
  s_barrier
  ds_read_b128 v[4:7], v84
  ds_read_b32 v25, v85
  ds_read_b32 v91, v92 offset:20
  s_waitcnt lgkmcnt(0)
  v_mul_f32 v4, v4, v25
  v_mul_f32 v5, v5, v25
  v_mul_f32 v6, v6, v25
  v_mul_f32 v7, v7, v25
  v_add_f32_dpp v4, v4, v4 quad_perm:[1,0,3,2] row_mask:0xf bank_mask:0xf
  v_add_f32_dpp v5, v5, v5 quad_perm:[1,0,3,2] row_mask:0xf bank_mask:0xf
  v_add_f32_dpp v6, v6, v6 quad_perm:[1,0,3,2] row_mask:0xf bank_mask:0xf
  v_add_f32_dpp v7, v7, v7 quad_perm:[1,0,3,2] row_mask:0xf bank_mask:0xf
  v_add_f32_dpp v4, v4, v4 quad_perm:[2,3,0,1] row_mask:0xf bank_mask:0xf
  v_add_f32_dpp v5, v5, v5 quad_perm:[2,3,0,1] row_mask:0xf bank_mask:0xf
  v_add_f32_dpp v6, v6, v6 quad_perm:[2,3,0,1] row_mask:0xf bank_mask:0xf
  v_add_f32_dpp v7, v7, v7 quad_perm:[2,3,0,1] row_mask:0xf bank_mask:0xf
  v_add_f32_dpp v4, v4, v4 row_half_mirror row_mask:0xf bank_mask:0xf
  v_add_f32_dpp v5, v5, v5 row_half_mirror row_mask:0xf bank_mask:0xf
  v_add_f32_dpp v6, v6, v6 row_half_mirror row_mask:0xf bank_mask:0xf
  v_add_f32_dpp v7, v7, v7 row_half_mirror row_mask:0xf bank_mask:0xf
  v_cvt_pk_bf16_f32 v4, v4, v5
  v_cvt_pk_bf16_f32 v5, v6, v7
  v_min_u32 v4, -2, v4
  v_min_u32 v5, -2, v5
  s_mov_b64 exec, s[70:71]
  buffer_store_dwordx2 v[4:5], v86, s[48:51], s96 offen offset:384 sc1
  s_mov_b64 exec, -1
  s_waitcnt vmcnt(0)
  buffer_load_dwordx4 v[64:67], v87, s[48:51], s97 offen offset:0 sc1
  buffer_load_dwordx4 v[68:71], v87, s[48:51], s97 offen offset:64 sc1
  buffer_load_dwordx4 v[72:75], v87, s[48:51], s97 offen offset:128 sc1
  buffer_load_dwordx4 v[76:79], v87, s[48:51], s97 offen offset:192 sc1
  s_barrier
  ds_read_b64_tr_b16 a[96:97], v82 offset:16384
  ds_read_b64_tr_b16 a[98:99], v82 offset:16640
  ds_read_b64_tr_b16 a[100:101], v26 offset:16384
  ds_read_b64_tr_b16 a[102:103], v26 offset:16640
  ds_read_b64_tr_b16 a[104:105], v27 offset:16384
  ds_read_b64_tr_b16 a[106:107], v27 offset:16640
  ds_read_b64_tr_b16 a[108:109], v28 offset:16384
  ds_read_b64_tr_b16 a[110:111], v28 offset:16640
  s_waitcnt lgkmcnt(7)
  ds_read_b64_tr_b16 a[112:113], v82 offset:24576
  ds_read_b64_tr_b16 a[114:115], v82 offset:24832
  ds_read_b64_tr_b16 a[116:117], v26 offset:24576
  ds_read_b64_tr_b16 a[118:119], v26 offset:24832
  ds_read_b64_tr_b16 a[120:121], v27 offset:24576
  ds_read_b64_tr_b16 a[122:123], v27 offset:24832
  ds_read_b64_tr_b16 a[124:125], v28 offset:24576
  ds_read_b64_tr_b16 a[126:127], v28 offset:24832
  s_branch L_gchk
L_gather:
  s_sleep 1
  buffer_load_dwordx4 v[64:67], v87, s[48:51], s97 offen offset:0 sc1
  buffer_load_dwordx4 v[68:71], v87, s[48:51], s97 offen offset:64 sc1
  buffer_load_dwordx4 v[72:75], v87, s[48:51], s97 offen offset:128 sc1
  buffer_load_dwordx4 v[76:79], v87, s[48:51], s97 offen offset:192 sc1
L_gchk:
  s_waitcnt vmcnt(0)
  v_max3_u32 v4, v64, v65, v66
  v_max3_u32 v5, v67, v68, v69
  v_max3_u32 v4, v4, v70, v71
  v_max3_u32 v5, v5, v72, v73
  v_max3_u32 v4, v4, v74, v75
  v_max3_u32 v5, v5, v76, v77
  v_max3_u32 v4, v4, v78, v79
  v_max_u32 v4, v4, v5
  v_cmp_eq_u32 s[86:87], -1, v4
  s_sub_u32 s68, s68, 1
  s_cbranch_scc1 L_gdone
  s_and_b64 exec, exec, s[86:87]
  s_cbranch_scc1 L_gather
L_gdone:
  s_mov_b64 exec, -1
  v_mfma_f32_16x16x32_bf16 v[112:115], v[64:67], a[64:67], 0
  v_mfma_f32_16x16x32_bf16 v[116:119], v[64:67], a[68:71], 0
  v_mfma_f32_16x16x32_bf16 v[120:123], v[64:67], a[72:75], 0
  v_mfma_f32_16x16x32_bf16 v[124:127], v[64:67], a[76:79], 0
  v_mfma_f32_16x16x32_bf16 v[112:115], v[68:71], a[80:83], v[112:115]
  v_mfma_f32_16x16x32_bf16 v[116:119], v[68:71], a[84:87], v[116:119]
  v_mfma_f32_16x16x32_bf16 v[120:123], v[68:71], a[88:91], v[120:123]
  v_mfma_f32_16x16x32_bf16 v[124:127], v[68:71], a[92:95], v[124:127]
  s_waitcnt lgkmcnt(0)
  v_mfma_f32_16x16x32_bf16 v[112:115], v[72:75], a[96:99], v[112:115]
  v_mfma_f32_16x16x32_bf16 v[116:119], v[72:75], a[100:103], v[116:119]
  v_mfma_f32_16x16x32_bf16 v[120:123], v[72:75], a[104:107], v[120:123]
  v_mfma_f32_16x16x32_bf16 v[124:127], v[72:75], a[108:111], v[124:127]
  v_mfma_f32_16x16x32_bf16 v[112:115], v[76:79], a[112:115], v[112:115]
  v_mfma_f32_16x16x32_bf16 v[116:119], v[76:79], a[116:119], v[116:119]
  v_mfma_f32_16x16x32_bf16 v[120:123], v[76:79], a[120:123], v[120:123]
  v_mfma_f32_16x16x32_bf16 v[124:127], v[76:79], a[124:127], v[124:127]
  s_mov_b32 s68, 65536
  v_readfirstlane_b32 s60, v91
  s_nop 0
  s_cmp_eq_u32 s60, 1
  s_nop 0
  v_add_f32 v4, v112, v113
  v_add_f32 v114, v114, v115
  v_add_f32 v116, v116, v117
  v_add_f32 v118, v118, v119
  v_add_f32 v5, v120, v121
  v_add_f32 v122, v122, v123
  v_add_f32 v124, v124, v125
  v_add_f32 v126, v126, v127
  v_add_f32_dpp v4, v114, v4 row_ror:8 row_mask:0xf bank_mask:0x3
  v_add_f32_dpp v4, v116, v118 row_ror:8 row_mask:0xf bank_mask:0xc
  v_add_f32_dpp v5, v122, v5 row_ror:8 row_mask:0xf bank_mask:0x3
  v_add_f32_dpp v5, v124, v126 row_ror:8 row_mask:0xf bank_mask:0xc
  v_min_u32 v4, -2, v4
  v_min_u32 v5, -2, v5
  s_cbranch_scc1 L_p2loc
  buffer_store_dwordx2 v[4:5], v88, s[48:51], s99 offen offset:896 sc1
  s_branch L_p2done
L_p2loc:
  buffer_store_dwordx2 v[4:5], v88, s[48:51], s99 offen offset:896
L_p2done:
  s_cmp_ge_u32 s3, 2
  s_cbranch_scc1 L_end
L_s3:
  s_sleep 1
  buffer_load_dwordx4 v[12:15], v8, s[48:51], s100 offen sc1
  s_waitcnt vmcnt(0)
  v_max3_u32 v10, v12, v13, v14
  v_max_u32 v10, v10, v15
  v_cmp_eq_u32 s[86:87], -1, v10
  s_sub_u32 s68, s68, 1
  s_cbranch_scc1 L_s3done
  s_and_b64 exec, exec, s[86:87]
  s_cbranch_scc1 L_s3
L_s3done:
  s_mov_b64 exec, -1
  v_add_f32_dpp v16, v12, v12 row_ror:8 row_mask:0xf bank_mask:0xf
  v_add_f32_dpp v17, v13, v13 row_ror:8 row_mask:0xf bank_mask:0xf
  v_add_f32_dpp v18, v14, v14 row_ror:8 row_mask:0xf bank_mask:0xf
  v_add_f32_dpp v19, v15, v15 row_ror:8 row_mask:0xf bank_mask:0xf
  v_add_f32_dpp v16, v16, v16 row_ror:4 row_mask:0xf bank_mask:0xf
  v_add_f32_dpp v17, v17, v17 row_ror:4 row_mask:0xf bank_mask:0xf
  v_add_f32_dpp v18, v18, v18 row_ror:4 row_mask:0xf bank_mask:0xf
  v_add_f32_dpp v19, v19, v19 row_ror:4 row_mask:0xf bank_mask:0xf
  v_add_f32_dpp v16, v16, v16 row_ror:2 row_mask:0xf bank_mask:0xf
  v_add_f32_dpp v17, v17, v17 row_ror:2 row_mask:0xf bank_mask:0xf
  v_add_f32_dpp v18, v18, v18 row_ror:2 row_mask:0xf bank_mask:0xf
  v_add_f32_dpp v19, v19, v19 row_ror:2 row_mask:0xf bank_mask:0xf
  v_add_f32_dpp v16, v16, v16 row_ror:1 row_mask:0xf bank_mask:0xf
  v_add_f32_dpp v17, v17, v17 row_ror:1 row_mask:0xf bank_mask:0xf
  v_add_f32_dpp v18, v18, v18 row_ror:1 row_mask:0xf bank_mask:0xf
  v_add_f32_dpp v19, v19, v19 row_ror:1 row_mask:0xf bank_mask:0xf
  v_cvt_pk_bf16_f32 v4, v16, v18
  v_cvt_pk_bf16_f32 v5, v17, v19
  v_cndmask_b32 v4, v4, v5, s[72:73]
  s_mov_b64 exec, s[74:75]
  buffer_store_dword v4, v9, s[52:55], s101 offen
  s_mov_b64 exec, -1
  s_endpgm
L_helper:
  v_lshlrev_b32 v21, 4, v1
  s_mul_i32 s96, s2, 2944
  s_add_u32 s96, s96, 2097152
  s_lshr_b32 s97, s2, 7
  s_lshl_b32 s97, s97, 3
  s_add_u32 s97, s97, s92
  s_lshl_b32 s97, s97, 4
  s_waitcnt lgkmcnt(0)
  s_mov_b32 s48, s28
  s_mov_b32 s49, s29
  s_mov_b32 s50, 0x800000
  s_mov_b32 s51, 0x00020000
  s_mov_b32 s52, s26
  s_mov_b32 s53, s27
  s_mov_b32 s54, 0x100
  s_mov_b32 s55, 0x00020000
  s_cmp_ge_u32 s2, 8
  s_cbranch_scc1 L_noinit
  v_mov_b32 v4, 0
  v_mov_b32 v5, 0
  v_mov_b32 v6, 0
  v_mov_b32 v7, 0
  s_lshl_b32 s60, s2, 12
  s_add_u32 s60, s60, 1572864
  s_lshl_b32 s61, s2, 2
  buffer_store_dwordx4 v[4:7], v21, s[48:51], s60 offen offset:0 sc1
  buffer_store_dwordx4 v[4:7], v21, s[48:51], s60 offen offset:1024 sc1
  buffer_store_dwordx4 v[4:7], v21, s[48:51], s60 offen offset:2048 sc1
  buffer_store_dwordx4 v[4:7], v21, s[48:51], s60 offen offset:3072 sc1
  s_add_u32 s60, s60, 32768
  buffer_store_dwordx4 v[4:7], v21, s[48:51], s60 offen offset:0 sc1
  buffer_store_dwordx4 v[4:7], v21, s[48:51], s60 offen offset:1024 sc1
  buffer_store_dwordx4 v[4:7], v21, s[48:51], s60 offen offset:2048 sc1
  buffer_store_dwordx4 v[4:7], v21, s[48:51], s60 offen offset:3072 sc1
  s_nop 1
  v_mov_b32 v5, 1
  s_waitcnt vmcnt(0)
  s_mov_b64 exec, 1
  buffer_store_dword v5, v4, s[52:55], s61 offen sc1
  s_mov_b64 exec, -1
L_noinit:
  v_mov_b32 v4, -1
  v_mov_b32 v5, -1
  v_mov_b32 v6, -1
  v_mov_b32 v7, -1
  buffer_store_dwordx4 v[4:7], v21, s[48:51], s96 offen sc1
  buffer_store_dwordx4 v[4:7], v21, s[48:51], s96 offen offset:1024 sc1
  s_mov_b32 s86, 0xffffffff
  s_mov_b32 s87, 0xffffff
  s_mov_b64 exec, s[86:87]
  buffer_store_dwordx4 v[4:7], v21, s[48:51], s96 offen offset:2048 sc1
  s_mov_b64 exec, -1
  v_mov_b32 v22, 156160
  ds_write_b128 v22, v[4:7]
  ds_write_b128 v22, v[4:7] offset:16
  v_mov_b32 v30, 0
  v_mov_b32 v31, 0
  v_mov_b32 v32, 0
  v_mov_b32 v33, 0
  ds_write_b128 v22, v[30:33] offset:64
  ds_write_b128 v22, v[30:33] offset:96
  v_mov_b32 v34, 0
  ds_write_b32 v22, v34 offset:80
  s_mov_b32 s70, 0x3030303
  s_mov_b32 s71, 0x3030303
  s_mov_b32 s72, 0xc0c0c0c
  s_mov_b32 s73, 0xc0c0c0c
  s_mov_b32 s74, 0x30303030
  s_mov_b32 s75, 0x30303030
  s_mov_b32 s76, 0xc0c0c0c0
  s_mov_b32 s77, 0xc0c0c0c0
  s_mov_b32 s86, 0xaaaaaaaa
  s_mov_b32 s87, 0xaaaaaaaa
  v_mov_b32 v4, 0x0c0c0100
  v_mov_b32 v5, 0x01000c0c
  v_cndmask_b32 v6, v4, v5, s[86:87]
  v_mov_b32 v4, 0x0c0c0302
  v_mov_b32 v5, 0x03020c0c
  v_cndmask_b32 v7, v4, v5, s[86:87]
  v_mov_b32 v4, 0x0c0c0c0c
  v_cndmask_b32 v8, v4, v6, s[70:71]
  v_cndmask_b32 v9, v4, v7, s[70:71]
  v_cndmask_b32 v10, v4, v6, s[72:73]
  v_cndmask_b32 v11, v4, v7, s[72:73]
  v_cndmask_b32 v12, v4, v6, s[74:75]
  v_cndmask_b32 v13, v4, v7, s[74:75]
  v_cndmask_b32 v14, v4, v6, s[76:77]
  v_cndmask_b32 v15, v4, v7, s[76:77]
  v_mov_b32 v4, 0x0000ffff
  v_mov_b32 v5, 0xffff0000
  v_cndmask_b32 v6, v4, v5, s[86:87]
  v_cndmask_b32 v16, 0, v6, s[70:71]
  v_cndmask_b32 v17, 0, v6, s[72:73]
  v_cndmask_b32 v18, 0, v6, s[74:75]
  v_cndmask_b32 v19, 0, v6, s[76:77]
  v_lshrrev_b32 v4, 3, v3
  v_lshlrev_b32 v22, 9, v4
  v_lshl_add_u32 v22, v2, 7, v22
  v_and_b32 v7, 7, v3
  v_lshl_add_u32 v22, v7, 4, v22
  v_add_u32 v23, 131072, v21
  s_lshl_b32 s66, s2, 7
  s_add_u32 s66, s66, 1572864
  v_lshlrev_b32 v20, 7, v7
  v_lshlrev_b32 v26, 2, v7
  v_lshlrev_b32 v28, 6, v4
  v_lshl_add_u32 v28, v7, 1, v28
  v_add_u32 v28, 155904, v28
  v_lshlrev_b32 v27, 11, v2
  v_lshl_add_u32 v27, v3, 4, v27
  v_lshrrev_b32 v4, 5, v1
  v_and_b32 v5, 31, v1
  v_lshlrev_b32 v25, 11, v4
  v_lshl_add_u32 v25, v5, 4, v25
  v_lshrrev_b32 v5, 3, v5
  v_lshlrev_b32 v24, 6, v5
  v_lshl_add_u32 v24, v7, 1, v24
  v_add_u32 v24, 155648, v24
  s_getreg_b32 s69, hwreg(HW_REG_XCC_ID, 0, 4)
  s_add_u32 s69, s69, 16
  v_mov_b32 v4, s69
  v_mov_b32 v5, 0
  s_lshl_b32 s60, s2, 11
  s_lshl_b32 s62, s94, 10
  s_add_u32 s62, s62, 1572864
  s_lshl_b32 s63, s94, 14
  s_lshl_b32 s64, s93, 9
  s_add_u32 s63, s63, s64
  s_and_b32 s64, s94, 1
  s_lshl_b32 s64, s64, 13
  s_add_u32 s63, s63, s64
  s_lshl_b32 s64, s95, 8
  s_add_u32 s64, s64, s63
  s_xor_b32 s64, s64, 8192
  s_waitcnt lgkmcnt(0)
  s_barrier
  ds_read_b128 v[64:67], v23 offset:0
  ds_read_b128 v[68:71], v23 offset:4096
  ds_read_b128 v[72:75], v23 offset:8192
  ds_read_b128 v[76:79], v23 offset:12288
  ds_read_b128 v[80:83], v23 offset:1024
  ds_read_b128 v[84:87], v23 offset:5120
  ds_read_b128 v[88:91], v23 offset:9216
  ds_read_b128 v[92:95], v23 offset:13312
  s_waitcnt lgkmcnt(4)
  v_add_f32 v64, v64, v68
  v_add_f32 v72, v72, v76
  v_add_f32 v65, v65, v69
  v_add_f32 v73, v73, v77
  v_add_f32 v66, v66, v70
  v_add_f32 v74, v74, v78
  v_add_f32 v67, v67, v71
  v_add_f32 v75, v75, v79
  v_add_f32 v64, v64, v72
  v_add_f32 v65, v65, v73
  v_add_f32 v66, v66, v74
  v_add_f32 v67, v67, v75
  buffer_store_dwordx4 v[64:67], v22, s[48:51], s60 offen offset:0 sc1
  s_waitcnt lgkmcnt(0)
  v_add_f32 v80, v80, v84
  v_add_f32 v88, v88, v92
  v_add_f32 v81, v81, v85
  v_add_f32 v89, v89, v93
  v_add_f32 v82, v82, v86
  v_add_f32 v90, v90, v94
  v_add_f32 v83, v83, v87
  v_add_f32 v91, v91, v95
  v_add_f32 v80, v80, v88
  v_add_f32 v81, v81, v89
  v_add_f32 v82, v82, v90
  v_add_f32 v83, v83, v91
  buffer_store_dwordx4 v[80:83], v22, s[48:51], s60 offen offset:1024 sc1
  s_mov_b32 s68, 65536
L_pi:
  buffer_load_dword v6, v26, s[52:55], 0 offen sc1
  s_waitcnt vmcnt(0)
  v_cmp_ne_u32 s[86:87], 1, v6
  s_nop 0
  s_cmp_eq_u64 s[86:87], 0
  s_cbranch_scc1 L_pi_ok
  s_sleep 4
  s_sub_u32 s68, s68, 1
  s_cmp_lg_u32 s68, 0
  s_cbranch_scc1 L_pi
L_pi_ok:
  s_mov_b64 exec, 1
  buffer_store_dword v4, v5, s[48:51], s66 offen sc1
  s_mov_b64 exec, -1
  s_mov_b32 s68, 65536
L_pq:
  buffer_load_dword v6, v20, s[48:51], s62 offen sc1
  s_waitcnt vmcnt(0)
  v_cmp_eq_u32 s[86:87], 0, v6
  s_nop 0
  s_cmp_eq_u64 s[86:87], 0
  s_cbranch_scc1 L_pq_ok
  s_sleep 4
  s_sub_u32 s68, s68, 1
  s_cmp_lg_u32 s68, 0
  s_cbranch_scc1 L_pq
L_pq_ok:
  buffer_load_dwordx4 v[64:67], v25, s[48:51], s63 offen sc1
  s_add_u32 s63, s63, 4096
  buffer_load_dwordx4 v[68:71], v25, s[48:51], s63 offen sc1
  buffer_load_dwordx4 v[80:83], v27, s[48:51], s64 offen sc1
  s_waitcnt vmcnt(1)
  v_add_f32 v64, v64, v68
  v_add_f32 v65, v65, v69
  v_add_f32 v66, v66, v70
  v_add_f32 v67, v67, v71
  v_mov_b32 v68, v64
  v_mov_b32 v69, v65
  v_mov_b32 v70, v66
  v_mov_b32 v71, v67
  v_permlane32_swap_b32 v68, v64
  v_permlane32_swap_b32 v69, v65
  v_permlane32_swap_b32 v70, v66
  v_permlane32_swap_b32 v71, v67
  v_add_f32 v64, v64, v68
  v_add_f32 v65, v65, v69
  v_add_f32 v66, v66, v70
  v_add_f32 v67, v67, v71
  v_cvt_pk_bf16_f32 v64, v64, v65
  v_cvt_pk_bf16_f32 v66, v66, v67
  ds_write_b16 v24, v64 offset:0
  ds_write_b16_d16_hi v24, v64 offset:16
  ds_write_b16 v24, v66 offset:32
  ds_write_b16_d16_hi v24, v66 offset:48
  s_waitcnt vmcnt(0)
  v_mov_b32 v84, v80
  s_nop 1
  v_permlane16_swap_b32 v84, v80
  v_add_f32 v80, v80, v84
  v_mov_b32 v84, v80
  s_nop 1
  v_permlane32_swap_b32 v84, v80
  v_add_f32 v80, v80, v84
  v_mov_b32 v85, v81
  s_nop 1
  v_permlane16_swap_b32 v85, v81
  v_add_f32 v81, v81, v85
  v_mov_b32 v85, v81
  s_nop 1
  v_permlane32_swap_b32 v85, v81
  v_add_f32 v81, v81, v85
  v_mov_b32 v86, v82
  s_nop 1
  v_permlane16_swap_b32 v86, v82
  v_add_f32 v82, v82, v86
  v_mov_b32 v86, v82
  s_nop 1
  v_permlane32_swap_b32 v86, v82
  v_add_f32 v82, v82, v86
  v_mov_b32 v87, v83
  s_nop 1
  v_permlane16_swap_b32 v87, v83
  v_add_f32 v83, v83, v87
  v_mov_b32 v87, v83
  s_nop 1
  v_permlane32_swap_b32 v87, v83
  v_add_f32 v83, v83, v87
  v_cvt_pk_bf16_f32 v80, v80, v81
  v_cvt_pk_bf16_f32 v82, v82, v83
  ds_write_b16 v28, v80 offset:0
  ds_write_b16_d16_hi v28, v80 offset:16
  ds_write_b16 v28, v82 offset:32
  ds_write_b16_d16_hi v28, v82 offset:48
  v_and_b32 v4, 0x70, v21
  v_add_u32 v5, 155904, v4
  ds_read_b128 v[80:83], v5
  s_waitcnt lgkmcnt(0)
  v_min_u32 v80, -2, v80
  v_min_u32 v81, -2, v81
  v_min_u32 v82, -2, v82
  v_min_u32 v83, -2, v83
  s_mov_b64 exec, 0xff
  buffer_store_dwordx4 v[80:83], v4, s[48:51], s96 offen offset:0 sc1
  s_mov_b64 exec, -1
  v_add_u32 v23, 65536, v21
  s_barrier
  ds_read_b128 a[0:3], v23 offset:32768
  ds_read_b128 a[4:7], v23 offset:33792
  ds_read_b128 a[8:11], v23 offset:34816
  ds_read_b128 a[12:15], v23 offset:35840
  ds_read_b128 a[16:19], v23 offset:36864
  ds_read_b128 a[20:23], v23 offset:37888
  ds_read_b128 a[24:27], v23 offset:38912
  ds_read_b128 a[28:31], v23 offset:39936
  s_waitcnt lgkmcnt(0)
  ds_read_b128 a[32:35], v23 offset:40960
  ds_read_b128 a[36:39], v23 offset:41984
  ds_read_b128 a[40:43], v23 offset:43008
  ds_read_b128 a[44:47], v23 offset:44032
  ds_read_b128 a[48:51], v23 offset:45056
  ds_read_b128 a[52:55], v23 offset:46080
  ds_read_b128 a[56:59], v23 offset:47104
  ds_read_b128 a[60:63], v23 offset:48128
  s_waitcnt lgkmcnt(0)
  ds_read_b128 a[64:67], v23 offset:49152
  ds_read_b128 a[68:71], v23 offset:50176
  ds_read_b128 a[72:75], v23 offset:51200
  ds_read_b128 a[76:79], v23 offset:52224
  ds_read_b128 a[80:83], v23 offset:53248
  ds_read_b128 a[84:87], v23 offset:54272
  ds_read_b128 a[88:91], v23 offset:55296
  ds_read_b128 a[92:95], v23 offset:56320
  s_waitcnt lgkmcnt(0)
  ds_read_b128 a[96:99], v23 offset:57344
  ds_read_b128 a[100:103], v23 offset:58368
  ds_read_b128 a[104:107], v23 offset:59392
  ds_read_b128 a[108:111], v23 offset:60416
  ds_read_b128 a[112:115], v23 offset:61440
  ds_read_b128 a[116:119], v23 offset:62464
  ds_read_b128 a[120:123], v23 offset:63488
  ds_read_b128 a[124:127], v23 offset:64512
  s_waitcnt lgkmcnt(0)
  s_and_b32 s61, s91, 15
  v_lshrrev_b32 v6, 2, v3
  v_and_b32 v7, 3, v3
  s_cmp_ge_u32 s2, 128
  s_cbranch_scc1 L_rpb_3
  v_lshl_add_u32 v5, v6, 6, v7
  s_lshl_b32 s60, s61, 2
  s_branch L_rpe_4
L_rpb_3:
  v_lshlrev_b32 v5, 3, v7
  v_and_b32 v7, 1, v6
  v_lshl_add_u32 v5, v7, 2, v5
  v_lshrrev_b32 v6, 1, v6
  v_lshl_add_u32 v5, v6, 7, v5
  s_and_b32 s60, s61, 3
  s_lshl_b32 s60, s60, 5
  s_lshr_b32 s61, s61, 2
  s_add_u32 s60, s60, s61
L_rpe_4:
  v_add_u32 v5, s60, v5
  v_add_u32 v4, s97, v3
  s_mov_b32 s86, 0xffff0000
  s_mov_b32 s87, 0x0
  v_cndmask_b32 v4, v4, v5, s[86:87]
  s_and_b32 s64, s2, 0x87
  v_lshl_add_u32 v5, v3, 3, s64
  s_mov_b32 s86, 0x0
  s_mov_b32 s87, 0xffff
  v_cndmask_b32 v4, v4, v5, s[86:87]
  s_xor_b32 s60, s2, 1
  v_mov_b32 v5, s60
  s_mov_b32 s86, 0x0
  s_mov_b32 s87, 0xffff0000
  v_cndmask_b32 v4, v4, v5, s[86:87]
  v_lshlrev_b32 v4, 7, v4
  s_mov_b32 s61, 1572864
  s_mov_b32 s68, 65536
L_pa:
  buffer_load_dword v6, v4, s[48:51], s61 offen sc1
  s_waitcnt vmcnt(0)
  v_cmp_eq_u32 s[86:87], 0, v6
  s_nop 0
  s_cmp_eq_u64 s[86:87], 0
  s_cbranch_scc1 L_pa_ok
  s_sleep 16
  s_sub_u32 s68, s68, 1
  s_cmp_lg_u32 s68, 0
  s_cbranch_scc1 L_pa
L_pa_ok:
  v_cmp_ne_u32 s[86:87], s69, v6
  s_nop 0
  s_and_b32 s60, s87, 0xffff
  s_cselect_b32 s60, 0, 1
  s_cselect_b32 s69, 0, 1
  v_mov_b32 v4, 156224
  v_mov_b32 v5, s60
  ds_write_b32 v4, v5 offset:20
  s_mul_i32 s98, s97, 2944
  s_add_u32 s98, s98, 2097152
  v_bfe_u32 v4, v3, 1, 2
  v_lshrrev_b32 v5, 3, v3
  v_lshl_add_u32 v28, v4, 1, v5
  v_mul_u32_u24 v4, 5888, v28
  v_lshl_add_u32 v4, v2, 5, v4
  v_and_b32 v5, 1, v3
  v_lshl_add_u32 v4, v5, 4, v4
  s_mov_b32 s68, 65536
L_q2:
  buffer_load_dwordx4 v[30:33], v4, s[48:51], s98 offen offset:0 sc1
  buffer_load_dwordx4 v[34:37], v4, s[48:51], s98 offen offset:2944 sc1
  s_waitcnt vmcnt(0)
  v_max3_u32 v6, v30, v31, v32
  v_max3_u32 v6, v6, v33, v34
  v_max3_u32 v6, v6, v35, v36
  v_max_u32 v6, v6, v37
  v_cmp_eq_u32 s[86:87], -1, v6
  s_nop 0
  s_cmp_eq_u64 s[86:87], 0
  s_cbranch_scc1 L_q2_ok
  s_sleep 16
  s_sub_u32 s68, s68, 1
  s_cmp_lg_u32 s68, 0
  s_cbranch_scc1 L_q2
L_q2_ok:
  v_mfma_f32_16x16x32_bf16 v[38:41], a[0:3], v[30:33], 0
  v_mfma_f32_16x16x32_bf16 v[38:41], a[4:7], v[34:37], v[38:41]
  v_mfma_f32_16x16x32_bf16 v[42:45], a[8:11], v[30:33], 0
  v_mfma_f32_16x16x32_bf16 v[42:45], a[12:15], v[34:37], v[42:45]
  s_nop 5
  v_mov_b32_dpp v64, v38 quad_perm:[0,0,2,2] row_mask:0xf bank_mask:0xf
  v_add_f32_dpp v64, v39, v64 quad_perm:[1,1,3,3] row_mask:0xf bank_mask:0xf
  v_mov_b32_dpp v65, v40 quad_perm:[0,0,2,2] row_mask:0xf bank_mask:0xf
  v_add_f32_dpp v65, v41, v65 quad_perm:[1,1,3,3] row_mask:0xf bank_mask:0xf
  v_mfma_f32_16x16x32_bf16 v[38:41], a[16:19], v[30:33], 0
  v_mfma_f32_16x16x32_bf16 v[38:41], a[20:23], v[34:37], v[38:41]
  v_mov_b32_dpp v66, v42 quad_perm:[0,0,2,2] row_mask:0xf bank_mask:0xf
  v_add_f32_dpp v66, v43, v66 quad_perm:[1,1,3,3] row_mask:0xf bank_mask:0xf
  v_mov_b32_dpp v67, v44 quad_perm:[0,0,2,2] row_mask:0xf bank_mask:0xf
  v_add_f32_dpp v67, v45, v67 quad_perm:[1,1,3,3] row_mask:0xf bank_mask:0xf
  v_mfma_f32_16x16x32_bf16 v[42:45], a[24:27], v[30:33], 0
  v_mfma_f32_16x16x32_bf16 v[42:45], a[28:31], v[34:37], v[42:45]
  s_nop 1
  v_mov_b32_dpp v68, v38 quad_perm:[0,0,2,2] row_mask:0xf bank_mask:0xf
  v_add_f32_dpp v68, v39, v68 quad_perm:[1,1,3,3] row_mask:0xf bank_mask:0xf
  v_mov_b32_dpp v69, v40 quad_perm:[0,0,2,2] row_mask:0xf bank_mask:0xf
  v_add_f32_dpp v69, v41, v69 quad_perm:[1,1,3,3] row_mask:0xf bank_mask:0xf
  v_mfma_f32_16x16x32_bf16 v[38:41], a[32:35], v[30:33], 0
  v_mfma_f32_16x16x32_bf16 v[38:41], a[36:39], v[34:37], v[38:41]
  v_mov_b32_dpp v70, v42 quad_perm:[0,0,2,2] row_mask:0xf bank_mask:0xf
  v_add_f32_dpp v70, v43, v70 quad_perm:[1,1,3,3] row_mask:0xf bank_mask:0xf
  v_mov_b32_dpp v71, v44 quad_perm:[0,0,2,2] row_mask:0xf bank_mask:0xf
  v_add_f32_dpp v71, v45, v71 quad_perm:[1,1,3,3] row_mask:0xf bank_mask:0xf
  v_mfma_f32_16x16x32_bf16 v[42:45], a[40:43], v[30:33], 0
  v_mfma_f32_16x16x32_bf16 v[42:45], a[44:47], v[34:37], v[42:45]
  s_nop 1
  v_mov_b32_dpp v72, v38 quad_perm:[0,0,2,2] row_mask:0xf bank_mask:0xf
  v_add_f32_dpp v72, v39, v72 quad_perm:[1,1,3,3] row_mask:0xf bank_mask:0xf
  v_mov_b32_dpp v73, v40 quad_perm:[0,0,2,2] row_mask:0xf bank_mask:0xf
  v_add_f32_dpp v73, v41, v73 quad_perm:[1,1,3,3] row_mask:0xf bank_mask:0xf
  v_mfma_f32_16x16x32_bf16 v[38:41], a[48:51], v[30:33], 0
  v_mfma_f32_16x16x32_bf16 v[38:41], a[52:55], v[34:37], v[38:41]
  v_mov_b32_dpp v74, v42 quad_perm:[0,0,2,2] row_mask:0xf bank_mask:0xf
  v_add_f32_dpp v74, v43, v74 quad_perm:[1,1,3,3] row_mask:0xf bank_mask:0xf
  v_mov_b32_dpp v75, v44 quad_perm:[0,0,2,2] row_mask:0xf bank_mask:0xf
  v_add_f32_dpp v75, v45, v75 quad_perm:[1,1,3,3] row_mask:0xf bank_mask:0xf
  v_mfma_f32_16x16x32_bf16 v[42:45], a[56:59], v[30:33], 0
  v_mfma_f32_16x16x32_bf16 v[42:45], a[60:63], v[34:37], v[42:45]
  s_nop 1
  v_mov_b32_dpp v76, v38 quad_perm:[0,0,2,2] row_mask:0xf bank_mask:0xf
  v_add_f32_dpp v76, v39, v76 quad_perm:[1,1,3,3] row_mask:0xf bank_mask:0xf
  v_mov_b32_dpp v77, v40 quad_perm:[0,0,2,2] row_mask:0xf bank_mask:0xf
  v_add_f32_dpp v77, v41, v77 quad_perm:[1,1,3,3] row_mask:0xf bank_mask:0xf
  v_mfma_f32_16x16x32_bf16 v[38:41], a[64:67], v[30:33], 0
  v_mfma_f32_16x16x32_bf16 v[38:41], a[68:71], v[34:37], v[38:41]
  v_mov_b32_dpp v78, v42 quad_perm:[0,0,2,2] row_mask:0xf bank_mask:0xf
  v_add_f32_dpp v78, v43, v78 quad_perm:[1,1,3,3] row_mask:0xf bank_mask:0xf
  v_mov_b32_dpp v79, v44 quad_perm:[0,0,2,2] row_mask:0xf bank_mask:0xf
  v_add_f32_dpp v79, v45, v79 quad_perm:[1,1,3,3] row_mask:0xf bank_mask:0xf
  v_mfma_f32_16x16x32_bf16 v[42:45], a[72:75], v[30:33], 0
  v_mfma_f32_16x16x32_bf16 v[42:45], a[76:79], v[34:37], v[42:45]
  s_nop 1
  v_mov_b32_dpp v80, v38 quad_perm:[0,0,2,2] row_mask:0xf bank_mask:0xf
  v_add_f32_dpp v80, v39, v80 quad_perm:[1,1,3,3] row_mask:0xf bank_mask:0xf
  v_mov_b32_dpp v81, v40 quad_perm:[0,0,2,2] row_mask:0xf bank_mask:0xf
  v_add_f32_dpp v81, v41, v81 quad_perm:[1,1,3,3] row_mask:0xf bank_mask:0xf
  v_mfma_f32_16x16x32_bf16 v[38:41], a[80:83], v[30:33], 0
  v_mfma_f32_16x16x32_bf16 v[38:41], a[84:87], v[34:37], v[38:41]
  v_mov_b32_dpp v82, v42 quad_perm:[0,0,2,2] row_mask:0xf bank_mask:0xf
  v_add_f32_dpp v82, v43, v82 quad_perm:[1,1,3,3] row_mask:0xf bank_mask:0xf
  v_mov_b32_dpp v83, v44 quad_perm:[0,0,2,2] row_mask:0xf bank_mask:0xf
  v_add_f32_dpp v83, v45, v83 quad_perm:[1,1,3,3] row_mask:0xf bank_mask:0xf
  v_mfma_f32_16x16x32_bf16 v[42:45], a[88:91], v[30:33], 0
  v_mfma_f32_16x16x32_bf16 v[42:45], a[92:95], v[34:37], v[42:45]
  s_nop 1
  v_mov_b32_dpp v84, v38 quad_perm:[0,0,2,2] row_mask:0xf bank_mask:0xf
  v_add_f32_dpp v84, v39, v84 quad_perm:[1,1,3,3] row_mask:0xf bank_mask:0xf
  v_mov_b32_dpp v85, v40 quad_perm:[0,0,2,2] row_mask:0xf bank_mask:0xf
  v_add_f32_dpp v85, v41, v85 quad_perm:[1,1,3,3] row_mask:0xf bank_mask:0xf
  v_mfma_f32_16x16x32_bf16 v[38:41], a[96:99], v[30:33], 0
  v_mfma_f32_16x16x32_bf16 v[38:41], a[100:103], v[34:37], v[38:41]
  v_mov_b32_dpp v86, v42 quad_perm:[0,0,2,2] row_mask:0xf bank_mask:0xf
  v_add_f32_dpp v86, v43, v86 quad_perm:[1,1,3,3] row_mask:0xf bank_mask:0xf
  v_mov_b32_dpp v87, v44 quad_perm:[0,0,2,2] row_mask:0xf bank_mask:0xf
  v_add_f32_dpp v87, v45, v87 quad_perm:[1,1,3,3] row_mask:0xf bank_mask:0xf
  v_mfma_f32_16x16x32_bf16 v[42:45], a[104:107], v[30:33], 0
  v_mfma_f32_16x16x32_bf16 v[42:45], a[108:111], v[34:37], v[42:45]
  s_nop 1
  v_mov_b32_dpp v88, v38 quad_perm:[0,0,2,2] row_mask:0xf bank_mask:0xf
  v_add_f32_dpp v88, v39, v88 quad_perm:[1,1,3,3] row_mask:0xf bank_mask:0xf
  v_mov_b32_dpp v89, v40 quad_perm:[0,0,2,2] row_mask:0xf bank_mask:0xf
  v_add_f32_dpp v89, v41, v89 quad_perm:[1,1,3,3] row_mask:0xf bank_mask:0xf
  v_mfma_f32_16x16x32_bf16 v[38:41], a[112:115], v[30:33], 0
  v_mfma_f32_16x16x32_bf16 v[38:41], a[116:119], v[34:37], v[38:41]
  v_mov_b32_dpp v90, v42 quad_perm:[0,0,2,2] row_mask:0xf bank_mask:0xf
  v_add_f32_dpp v90, v43, v90 quad_perm:[1,1,3,3] row_mask:0xf bank_mask:0xf
  v_mov_b32_dpp v91, v44 quad_perm:[0,0,2,2] row_mask:0xf bank_mask:0xf
  v_add_f32_dpp v91, v45, v91 quad_perm:[1,1,3,3] row_mask:0xf bank_mask:0xf
  v_mfma_f32_16x16x32_bf16 v[42:45], a[120:123], v[30:33], 0
  v_mfma_f32_16x16x32_bf16 v[42:45], a[124:127], v[34:37], v[42:45]
  s_nop 1
  v_mov_b32_dpp v92, v38 quad_perm:[0,0,2,2] row_mask:0xf bank_mask:0xf
  v_add_f32_dpp v92, v39, v92 quad_perm:[1,1,3,3] row_mask:0xf bank_mask:0xf
  v_mov_b32_dpp v93, v40 quad_perm:[0,0,2,2] row_mask:0xf bank_mask:0xf
  v_add_f32_dpp v93, v41, v93 quad_perm:[1,1,3,3] row_mask:0xf bank_mask:0xf
  s_nop 1
  v_mov_b32_dpp v94, v42 quad_perm:[0,0,2,2] row_mask:0xf bank_mask:0xf
  v_add_f32_dpp v94, v43, v94 quad_perm:[1,1,3,3] row_mask:0xf bank_mask:0xf
  v_mov_b32_dpp v95, v44 quad_perm:[0,0,2,2] row_mask:0xf bank_mask:0xf
  v_add_f32_dpp v95, v45, v95 quad_perm:[1,1,3,3] row_mask:0xf bank_mask:0xf
  ds_read_b128 a[0:3], v23 offset:0
  ds_read_b128 a[4:7], v23 offset:1024
  ds_read_b128 a[8:11], v23 offset:2048
  ds_read_b128 a[12:15], v23 offset:3072
  ds_read_b128 a[16:19], v23 offset:4096
  ds_read_b128 a[20:23], v23 offset:5120
  ds_read_b128 a[24:27], v23 offset:6144
  ds_read_b128 a[28:31], v23 offset:7168
  s_waitcnt lgkmcnt(0)
  ds_read_b128 a[32:35], v23 offset:8192
  ds_read_b128 a[36:39], v23 offset:9216
  ds_read_b128 a[40:43], v23 offset:10240
  ds_read_b128 a[44:47], v23 offset:11264
  ds_read_b128 a[48:51], v23 offset:12288
  ds_read_b128 a[52:55], v23 offset:13312
  ds_read_b128 a[56:59], v23 offset:14336
  ds_read_b128 a[60:63], v23 offset:15360
  s_waitcnt lgkmcnt(0)
  ds_read_b128 a[64:67], v23 offset:16384
  ds_read_b128 a[68:71], v23 offset:17408
  ds_read_b128 a[72:75], v23 offset:18432
  ds_read_b128 a[76:79], v23 offset:19456
  ds_read_b128 a[80:83], v23 offset:20480
  ds_read_b128 a[84:87], v23 offset:21504
  ds_read_b128 a[88:91], v23 offset:22528
  ds_read_b128 a[92:95], v23 offset:23552
  s_waitcnt lgkmcnt(0)
  ds_read_b128 a[96:99], v23 offset:24576
  ds_read_b128 a[100:103], v23 offset:25600
  ds_read_b128 a[104:107], v23 offset:26624
  ds_read_b128 a[108:111], v23 offset:27648
  ds_read_b128 a[112:115], v23 offset:28672
  ds_read_b128 a[116:119], v23 offset:29696
  ds_read_b128 a[120:123], v23 offset:30720
  ds_read_b128 a[124:127], v23 offset:31744
  s_waitcnt lgkmcnt(0)
  v_max_f32 v46, v64, v65
  v_max3_f32 v46, v46, v66, v67
  v_max3_f32 v46, v46, v68, v69
  v_max3_f32 v46, v46, v70, v71
  v_max3_f32 v46, v46, v72, v73
  v_max3_f32 v46, v46, v74, v75
  v_max3_f32 v46, v46, v76, v77
  v_max3_f32 v46, v46, v78, v79
  v_max3_f32 v46, v46, v80, v81
  v_max3_f32 v46, v46, v82, v83
  v_max3_f32 v46, v46, v84, v85
  v_max3_f32 v46, v46, v86, v87
  v_max3_f32 v46, v46, v88, v89
  v_max3_f32 v46, v46, v90, v91
  v_max3_f32 v46, v46, v92, v93
  v_max3_f32 v46, v46, v94, v95
  v_mov_b32 v4, v46
  s_nop 1
  v_permlane16_swap_b32 v4, v46
  v_max_f32 v46, v46, v4
  v_mov_b32 v4, v46
  s_nop 1
  v_permlane32_swap_b32 v4, v46
  v_max_f32 v46, v46, v4
  v_mul_f32 v46, s67, v46
  v_sub_f32 v48, 0, v46
  v_fma_f32 v64, v64, s67, v48
  v_fma_f32 v65, v65, s67, v48
  v_fma_f32 v66, v66, s67, v48
  v_fma_f32 v67, v67, s67, v48
  v_fma_f32 v68, v68, s67, v48
  v_fma_f32 v69, v69, s67, v48
  v_fma_f32 v70, v70, s67, v48
  v_fma_f32 v71, v71, s67, v48
  v_fma_f32 v72, v72, s67, v48
  v_fma_f32 v73, v73, s67, v48
  v_fma_f32 v74, v74, s67, v48
  v_fma_f32 v75, v75, s67, v48
  v_fma_f32 v76, v76, s67, v48
  v_fma_f32 v77, v77, s67, v48
  v_fma_f32 v78, v78, s67, v48
  v_fma_f32 v79, v79, s67, v48
  v_fma_f32 v80, v80, s67, v48
  v_fma_f32 v81, v81, s67, v48
  v_fma_f32 v82, v82, s67, v48
  v_fma_f32 v83, v83, s67, v48
  v_fma_f32 v84, v84, s67, v48
  v_fma_f32 v85, v85, s67, v48
  v_fma_f32 v86, v86, s67, v48
  v_fma_f32 v87, v87, s67, v48
  v_fma_f32 v88, v88, s67, v48
  v_fma_f32 v89, v89, s67, v48
  v_fma_f32 v90, v90, s67, v48
  v_fma_f32 v91, v91, s67, v48
  v_fma_f32 v92, v92, s67, v48
  v_fma_f32 v93, v93, s67, v48
  v_fma_f32 v94, v94, s67, v48
  v_fma_f32 v95, v95, s67, v48
  v_exp_f32 v64, v64
  v_exp_f32 v65, v65
  v_exp_f32 v66, v66
  v_exp_f32 v67, v67
  v_exp_f32 v68, v68
  v_exp_f32 v69, v69
  v_exp_f32 v70, v70
  v_exp_f32 v71, v71
  v_exp_f32 v72, v72
  v_exp_f32 v73, v73
  v_exp_f32 v74, v74
  v_exp_f32 v75, v75
  v_exp_f32 v76, v76
  v_exp_f32 v77, v77
  v_exp_f32 v78, v78
  v_exp_f32 v79, v79
  v_exp_f32 v80, v80
  v_exp_f32 v81, v81
  v_exp_f32 v82, v82
  v_exp_f32 v83, v83
  v_exp_f32 v84, v84
  v_exp_f32 v85, v85
  v_exp_f32 v86, v86
  v_exp_f32 v87, v87
  v_exp_f32 v88, v88
  v_exp_f32 v89, v89
  v_exp_f32 v90, v90
  v_exp_f32 v91, v91
  v_exp_f32 v92, v92
  v_exp_f32 v93, v93
  v_exp_f32 v94, v94
  v_exp_f32 v95, v95
  v_add_f32 v47, v64, v65
  v_add_f32 v47, v47, v66
  v_add_f32 v47, v47, v67
  v_add_f32 v47, v47, v68
  v_add_f32 v47, v47, v69
  v_add_f32 v47, v47, v70
  v_add_f32 v47, v47, v71
  v_add_f32 v47, v47, v72
  v_add_f32 v47, v47, v73
  v_add_f32 v47, v47, v74
  v_add_f32 v47, v47, v75
  v_add_f32 v47, v47, v76
  v_add_f32 v47, v47, v77
  v_add_f32 v47, v47, v78
  v_add_f32 v47, v47, v79
  v_add_f32 v47, v47, v80
  v_add_f32 v47, v47, v81
  v_add_f32 v47, v47, v82
  v_add_f32 v47, v47, v83
  v_add_f32 v47, v47, v84
  v_add_f32 v47, v47, v85
  v_add_f32 v47, v47, v86
  v_add_f32 v47, v47, v87
  v_add_f32 v47, v47, v88
  v_add_f32 v47, v47, v89
  v_add_f32 v47, v47, v90
  v_add_f32 v47, v47, v91
  v_add_f32 v47, v47, v92
  v_add_f32 v47, v47, v93
  v_add_f32 v47, v47, v94
  v_add_f32 v47, v47, v95
  v_mov_b32 v4, v47
  s_nop 1
  v_permlane16_swap_b32 v4, v47
  v_add_f32 v47, v47, v4
  v_mov_b32 v4, v47
  s_nop 1
  v_permlane32_swap_b32 v4, v47
  v_add_f32 v47, v47, v4
  v_cvt_pk_bf16_f32 v64, v64, v64
  v_cvt_pk_bf16_f32 v65, v65, v65
  v_cvt_pk_bf16_f32 v66, v66, v66
  v_cvt_pk_bf16_f32 v67, v67, v67
  v_cvt_pk_bf16_f32 v68, v68, v68
  v_cvt_pk_bf16_f32 v69, v69, v69
  v_cvt_pk_bf16_f32 v70, v70, v70
  v_cvt_pk_bf16_f32 v71, v71, v71
  v_cvt_pk_bf16_f32 v72, v72, v72
  v_cvt_pk_bf16_f32 v73, v73, v73
  v_cvt_pk_bf16_f32 v74, v74, v74
  v_cvt_pk_bf16_f32 v75, v75, v75
  v_cvt_pk_bf16_f32 v76, v76, v76
  v_cvt_pk_bf16_f32 v77, v77, v77
  v_cvt_pk_bf16_f32 v78, v78, v78
  v_cvt_pk_bf16_f32 v79, v79, v79
  v_cvt_pk_bf16_f32 v80, v80, v80
  v_cvt_pk_bf16_f32 v81, v81, v81
  v_cvt_pk_bf16_f32 v82, v82, v82
  v_cvt_pk_bf16_f32 v83, v83, v83
  v_cvt_pk_bf16_f32 v84, v84, v84
  v_cvt_pk_bf16_f32 v85, v85, v85
  v_cvt_pk_bf16_f32 v86, v86, v86
  v_cvt_pk_bf16_f32 v87, v87, v87
  v_cvt_pk_bf16_f32 v88, v88, v88
  v_cvt_pk_bf16_f32 v89, v89, v89
  v_cvt_pk_bf16_f32 v90, v90, v90
  v_cvt_pk_bf16_f32 v91, v91, v91
  v_cvt_pk_bf16_f32 v92, v92, v92
  v_cvt_pk_bf16_f32 v93, v93, v93
  v_cvt_pk_bf16_f32 v94, v94, v94
  v_cvt_pk_bf16_f32 v95, v95, v95
  v_and_b32 v50, v64, v16
  v_and_b32_dpp v51, v64, v17 row_shr:2 row_mask:0xf bank_mask:0xf bound_ctrl:0
  v_and_b32_dpp v52, v64, v18 row_shr:4 row_mask:0xf bank_mask:0xf bound_ctrl:0
  v_and_b32_dpp v53, v64, v19 row_shr:6 row_mask:0xf bank_mask:0xf bound_ctrl:0
  s_nop 1
  v_mfma_f32_16x16x32_bf16 v[96:99], a[0:3], v[50:53], 0
  v_and_b32_dpp v54, v64, v16 row_shl:2 row_mask:0xf bank_mask:0xf bound_ctrl:0
  v_and_b32 v55, v64, v17
  v_and_b32_dpp v56, v64, v18 row_shr:2 row_mask:0xf bank_mask:0xf bound_ctrl:0
  v_and_b32_dpp v57, v64, v19 row_shr:4 row_mask:0xf bank_mask:0xf bound_ctrl:0
  s_nop 1
  v_mfma_f32_16x16x32_bf16 v[100:103], a[0:3], v[54:57], 0
  v_and_b32_dpp v50, v64, v16 row_shl:4 row_mask:0xf bank_mask:0xf bound_ctrl:0
  v_and_b32_dpp v51, v64, v17 row_shl:2 row_mask:0xf bank_mask:0xf bound_ctrl:0
  v_and_b32 v52, v64, v18
  v_and_b32_dpp v53, v64, v19 row_shr:2 row_mask:0xf bank_mask:0xf bound_ctrl:0
  s_nop 1
  v_mfma_f32_16x16x32_bf16 v[104:107], a[0:3], v[50:53], 0
  v_and_b32_dpp v54, v64, v16 row_shl:6 row_mask:0xf bank_mask:0xf bound_ctrl:0
  v_and_b32_dpp v55, v64, v17 row_shl:4 row_mask:0xf bank_mask:0xf bound_ctrl:0
  v_and_b32_dpp v56, v64, v18 row_shl:2 row_mask:0xf bank_mask:0xf bound_ctrl:0
  v_and_b32 v57, v64, v19
  s_nop 1
  v_mfma_f32_16x16x32_bf16 v[108:111], a[0:3], v[54:57], 0
  v_and_b32 v50, v65, v16
  v_and_b32_dpp v51, v65, v17 row_shr:2 row_mask:0xf bank_mask:0xf bound_ctrl:0
  v_and_b32_dpp v52, v65, v18 row_shr:4 row_mask:0xf bank_mask:0xf bound_ctrl:0
  v_and_b32_dpp v53, v65, v19 row_shr:6 row_mask:0xf bank_mask:0xf bound_ctrl:0
  s_nop 1
  v_mfma_f32_16x16x32_bf16 v[96:99], a[4:7], v[50:53], v[96:99]
  v_and_b32_dpp v54, v65, v16 row_shl:2 row_mask:0xf bank_mask:0xf bound_ctrl:0
  v_and_b32 v55, v65, v17
  v_and_b32_dpp v56, v65, v18 row_shr:2 row_mask:0xf bank_mask:0xf bound_ctrl:0
  v_and_b32_dpp v57, v65, v19 row_shr:4 row_mask:0xf bank_mask:0xf bound_ctrl:0
  s_nop 1
  v_mfma_f32_16x16x32_bf16 v[100:103], a[4:7], v[54:57], v[100:103]
  v_and_b32_dpp v50, v65, v16 row_shl:4 row_mask:0xf bank_mask:0xf bound_ctrl:0
  v_and_b32_dpp v51, v65, v17 row_shl:2 row_mask:0xf bank_mask:0xf bound_ctrl:0
  v_and_b32 v52, v65, v18
  v_and_b32_dpp v53, v65, v19 row_shr:2 row_mask:0xf bank_mask:0xf bound_ctrl:0
  s_nop 1
  v_mfma_f32_16x16x32_bf16 v[104:107], a[4:7], v[50:53], v[104:107]
  v_and_b32_dpp v54, v65, v16 row_shl:6 row_mask:0xf bank_mask:0xf bound_ctrl:0
  v_and_b32_dpp v55, v65, v17 row_shl:4 row_mask:0xf bank_mask:0xf bound_ctrl:0
  v_and_b32_dpp v56, v65, v18 row_shl:2 row_mask:0xf bank_mask:0xf bound_ctrl:0
  v_and_b32 v57, v65, v19
  s_nop 1
  v_mfma_f32_16x16x32_bf16 v[108:111], a[4:7], v[54:57], v[108:111]
  v_and_b32 v50, v66, v16
  v_and_b32_dpp v51, v66, v17 row_shr:2 row_mask:0xf bank_mask:0xf bound_ctrl:0
  v_and_b32_dpp v52, v66, v18 row_shr:4 row_mask:0xf bank_mask:0xf bound_ctrl:0
  v_and_b32_dpp v53, v66, v19 row_shr:6 row_mask:0xf bank_mask:0xf bound_ctrl:0
  s_nop 1
  v_mfma_f32_16x16x32_bf16 v[96:99], a[8:11], v[50:53], v[96:99]
  v_and_b32_dpp v54, v66, v16 row_shl:2 row_mask:0xf bank_mask:0xf bound_ctrl:0
  v_and_b32 v55, v66, v17
  v_and_b32_dpp v56, v66, v18 row_shr:2 row_mask:0xf bank_mask:0xf bound_ctrl:0
  v_and_b32_dpp v57, v66, v19 row_shr:4 row_mask:0xf bank_mask:0xf bound_ctrl:0
  s_nop 1
  v_mfma_f32_16x16x32_bf16 v[100:103], a[8:11], v[54:57], v[100:103]
  v_and_b32_dpp v50, v66, v16 row_shl:4 row_mask:0xf bank_mask:0xf bound_ctrl:0
  v_and_b32_dpp v51, v66, v17 row_shl:2 row_mask:0xf bank_mask:0xf bound_ctrl:0
  v_and_b32 v52, v66, v18
  v_and_b32_dpp v53, v66, v19 row_shr:2 row_mask:0xf bank_mask:0xf bound_ctrl:0
  s_nop 1
  v_mfma_f32_16x16x32_bf16 v[104:107], a[8:11], v[50:53], v[104:107]
  v_and_b32_dpp v54, v66, v16 row_shl:6 row_mask:0xf bank_mask:0xf bound_ctrl:0
  v_and_b32_dpp v55, v66, v17 row_shl:4 row_mask:0xf bank_mask:0xf bound_ctrl:0
  v_and_b32_dpp v56, v66, v18 row_shl:2 row_mask:0xf bank_mask:0xf bound_ctrl:0
  v_and_b32 v57, v66, v19
  s_nop 1
  v_mfma_f32_16x16x32_bf16 v[108:111], a[8:11], v[54:57], v[108:111]
  v_and_b32 v50, v67, v16
  v_and_b32_dpp v51, v67, v17 row_shr:2 row_mask:0xf bank_mask:0xf bound_ctrl:0
  v_and_b32_dpp v52, v67, v18 row_shr:4 row_mask:0xf bank_mask:0xf bound_ctrl:0
  v_and_b32_dpp v53, v67, v19 row_shr:6 row_mask:0xf bank_mask:0xf bound_ctrl:0
  s_nop 1
  v_mfma_f32_16x16x32_bf16 v[96:99], a[12:15], v[50:53], v[96:99]
  v_and_b32_dpp v54, v67, v16 row_shl:2 row_mask:0xf bank_mask:0xf bound_ctrl:0
  v_and_b32 v55, v67, v17
  v_and_b32_dpp v56, v67, v18 row_shr:2 row_mask:0xf bank_mask:0xf bound_ctrl:0
  v_and_b32_dpp v57, v67, v19 row_shr:4 row_mask:0xf bank_mask:0xf bound_ctrl:0
  s_nop 1
  v_mfma_f32_16x16x32_bf16 v[100:103], a[12:15], v[54:57], v[100:103]
  v_and_b32_dpp v50, v67, v16 row_shl:4 row_mask:0xf bank_mask:0xf bound_ctrl:0
  v_and_b32_dpp v51, v67, v17 row_shl:2 row_mask:0xf bank_mask:0xf bound_ctrl:0
  v_and_b32 v52, v67, v18
  v_and_b32_dpp v53, v67, v19 row_shr:2 row_mask:0xf bank_mask:0xf bound_ctrl:0
  s_nop 1
  v_mfma_f32_16x16x32_bf16 v[104:107], a[12:15], v[50:53], v[104:107]
  v_and_b32_dpp v54, v67, v16 row_shl:6 row_mask:0xf bank_mask:0xf bound_ctrl:0
  v_and_b32_dpp v55, v67, v17 row_shl:4 row_mask:0xf bank_mask:0xf bound_ctrl:0
  v_and_b32_dpp v56, v67, v18 row_shl:2 row_mask:0xf bank_mask:0xf bound_ctrl:0
  v_and_b32 v57, v67, v19
  s_nop 1
  v_mfma_f32_16x16x32_bf16 v[108:111], a[12:15], v[54:57], v[108:111]
  v_and_b32 v50, v68, v16
  v_and_b32_dpp v51, v68, v17 row_shr:2 row_mask:0xf bank_mask:0xf bound_ctrl:0
  v_and_b32_dpp v52, v68, v18 row_shr:4 row_mask:0xf bank_mask:0xf bound_ctrl:0
  v_and_b32_dpp v53, v68, v19 row_shr:6 row_mask:0xf bank_mask:0xf bound_ctrl:0
  s_nop 1
  v_mfma_f32_16x16x32_bf16 v[96:99], a[16:19], v[50:53], v[96:99]
  v_and_b32_dpp v54, v68, v16 row_shl:2 row_mask:0xf bank_mask:0xf bound_ctrl:0
  v_and_b32 v55, v68, v17
  v_and_b32_dpp v56, v68, v18 row_shr:2 row_mask:0xf bank_mask:0xf bound_ctrl:0
  v_and_b32_dpp v57, v68, v19 row_shr:4 row_mask:0xf bank_mask:0xf bound_ctrl:0
  s_nop 1
  v_mfma_f32_16x16x32_bf16 v[100:103], a[16:19], v[54:57], v[100:103]
  v_and_b32_dpp v50, v68, v16 row_shl:4 row_mask:0xf bank_mask:0xf bound_ctrl:0
  v_and_b32_dpp v51, v68, v17 row_shl:2 row_mask:0xf bank_mask:0xf bound_ctrl:0
  v_and_b32 v52, v68, v18
  v_and_b32_dpp v53, v68, v19 row_shr:2 row_mask:0xf bank_mask:0xf bound_ctrl:0
  s_nop 1
  v_mfma_f32_16x16x32_bf16 v[104:107], a[16:19], v[50:53], v[104:107]
  v_and_b32_dpp v54, v68, v16 row_shl:6 row_mask:0xf bank_mask:0xf bound_ctrl:0
  v_and_b32_dpp v55, v68, v17 row_shl:4 row_mask:0xf bank_mask:0xf bound_ctrl:0
  v_and_b32_dpp v56, v68, v18 row_shl:2 row_mask:0xf bank_mask:0xf bound_ctrl:0
  v_and_b32 v57, v68, v19
  s_nop 1
  v_mfma_f32_16x16x32_bf16 v[108:111], a[16:19], v[54:57], v[108:111]
  v_and_b32 v50, v69, v16
  v_and_b32_dpp v51, v69, v17 row_shr:2 row_mask:0xf bank_mask:0xf bound_ctrl:0
  v_and_b32_dpp v52, v69, v18 row_shr:4 row_mask:0xf bank_mask:0xf bound_ctrl:0
  v_and_b32_dpp v53, v69, v19 row_shr:6 row_mask:0xf bank_mask:0xf bound_ctrl:0
  s_nop 1
  v_mfma_f32_16x16x32_bf16 v[96:99], a[20:23], v[50:53], v[96:99]
  v_and_b32_dpp v54, v69, v16 row_shl:2 row_mask:0xf bank_mask:0xf bound_ctrl:0
  v_and_b32 v55, v69, v17
  v_and_b32_dpp v56, v69, v18 row_shr:2 row_mask:0xf bank_mask:0xf bound_ctrl:0
  v_and_b32_dpp v57, v69, v19 row_shr:4 row_mask:0xf bank_mask:0xf bound_ctrl:0
  s_nop 1
  v_mfma_f32_16x16x32_bf16 v[100:103], a[20:23], v[54:57], v[100:103]
  v_and_b32_dpp v50, v69, v16 row_shl:4 row_mask:0xf bank_mask:0xf bound_ctrl:0
  v_and_b32_dpp v51, v69, v17 row_shl:2 row_mask:0xf bank_mask:0xf bound_ctrl:0
  v_and_b32 v52, v69, v18
  v_and_b32_dpp v53, v69, v19 row_shr:2 row_mask:0xf bank_mask:0xf bound_ctrl:0
  s_nop 1
  v_mfma_f32_16x16x32_bf16 v[104:107], a[20:23], v[50:53], v[104:107]
  v_and_b32_dpp v54, v69, v16 row_shl:6 row_mask:0xf bank_mask:0xf bound_ctrl:0
  v_and_b32_dpp v55, v69, v17 row_shl:4 row_mask:0xf bank_mask:0xf bound_ctrl:0
  v_and_b32_dpp v56, v69, v18 row_shl:2 row_mask:0xf bank_mask:0xf bound_ctrl:0
  v_and_b32 v57, v69, v19
  s_nop 1
  v_mfma_f32_16x16x32_bf16 v[108:111], a[20:23], v[54:57], v[108:111]
  v_and_b32 v50, v70, v16
  v_and_b32_dpp v51, v70, v17 row_shr:2 row_mask:0xf bank_mask:0xf bound_ctrl:0
  v_and_b32_dpp v52, v70, v18 row_shr:4 row_mask:0xf bank_mask:0xf bound_ctrl:0
  v_and_b32_dpp v53, v70, v19 row_shr:6 row_mask:0xf bank_mask:0xf bound_ctrl:0
  s_nop 1
  v_mfma_f32_16x16x32_bf16 v[96:99], a[24:27], v[50:53], v[96:99]
  v_and_b32_dpp v54, v70, v16 row_shl:2 row_mask:0xf bank_mask:0xf bound_ctrl:0
  v_and_b32 v55, v70, v17
  v_and_b32_dpp v56, v70, v18 row_shr:2 row_mask:0xf bank_mask:0xf bound_ctrl:0
  v_and_b32_dpp v57, v70, v19 row_shr:4 row_mask:0xf bank_mask:0xf bound_ctrl:0
  s_nop 1
  v_mfma_f32_16x16x32_bf16 v[100:103], a[24:27], v[54:57], v[100:103]
  v_and_b32_dpp v50, v70, v16 row_shl:4 row_mask:0xf bank_mask:0xf bound_ctrl:0
  v_and_b32_dpp v51, v70, v17 row_shl:2 row_mask:0xf bank_mask:0xf bound_ctrl:0
  v_and_b32 v52, v70, v18
  v_and_b32_dpp v53, v70, v19 row_shr:2 row_mask:0xf bank_mask:0xf bound_ctrl:0
  s_nop 1
  v_mfma_f32_16x16x32_bf16 v[104:107], a[24:27], v[50:53], v[104:107]
  v_and_b32_dpp v54, v70, v16 row_shl:6 row_mask:0xf bank_mask:0xf bound_ctrl:0
  v_and_b32_dpp v55, v70, v17 row_shl:4 row_mask:0xf bank_mask:0xf bound_ctrl:0
  v_and_b32_dpp v56, v70, v18 row_shl:2 row_mask:0xf bank_mask:0xf bound_ctrl:0
  v_and_b32 v57, v70, v19
  s_nop 1
  v_mfma_f32_16x16x32_bf16 v[108:111], a[24:27], v[54:57], v[108:111]
  v_and_b32 v50, v71, v16
  v_and_b32_dpp v51, v71, v17 row_shr:2 row_mask:0xf bank_mask:0xf bound_ctrl:0
  v_and_b32_dpp v52, v71, v18 row_shr:4 row_mask:0xf bank_mask:0xf bound_ctrl:0
  v_and_b32_dpp v53, v71, v19 row_shr:6 row_mask:0xf bank_mask:0xf bound_ctrl:0
  s_nop 1
  v_mfma_f32_16x16x32_bf16 v[96:99], a[28:31], v[50:53], v[96:99]
  v_and_b32_dpp v54, v71, v16 row_shl:2 row_mask:0xf bank_mask:0xf bound_ctrl:0
  v_and_b32 v55, v71, v17
  v_and_b32_dpp v56, v71, v18 row_shr:2 row_mask:0xf bank_mask:0xf bound_ctrl:0
  v_and_b32_dpp v57, v71, v19 row_shr:4 row_mask:0xf bank_mask:0xf bound_ctrl:0
  s_nop 1
  v_mfma_f32_16x16x32_bf16 v[100:103], a[28:31], v[54:57], v[100:103]
  v_and_b32_dpp v50, v71, v16 row_shl:4 row_mask:0xf bank_mask:0xf bound_ctrl:0
  v_and_b32_dpp v51, v71, v17 row_shl:2 row_mask:0xf bank_mask:0xf bound_ctrl:0
  v_and_b32 v52, v71, v18
  v_and_b32_dpp v53, v71, v19 row_shr:2 row_mask:0xf bank_mask:0xf bound_ctrl:0
  s_nop 1
  v_mfma_f32_16x16x32_bf16 v[104:107], a[28:31], v[50:53], v[104:107]
  v_and_b32_dpp v54, v71, v16 row_shl:6 row_mask:0xf bank_mask:0xf bound_ctrl:0
  v_and_b32_dpp v55, v71, v17 row_shl:4 row_mask:0xf bank_mask:0xf bound_ctrl:0
  v_and_b32_dpp v56, v71, v18 row_shl:2 row_mask:0xf bank_mask:0xf bound_ctrl:0
  v_and_b32 v57, v71, v19
  s_nop 1
  v_mfma_f32_16x16x32_bf16 v[108:111], a[28:31], v[54:57], v[108:111]
  v_and_b32 v50, v72, v16
  v_and_b32_dpp v51, v72, v17 row_shr:2 row_mask:0xf bank_mask:0xf bound_ctrl:0
  v_and_b32_dpp v52, v72, v18 row_shr:4 row_mask:0xf bank_mask:0xf bound_ctrl:0
  v_and_b32_dpp v53, v72, v19 row_shr:6 row_mask:0xf bank_mask:0xf bound_ctrl:0
  s_nop 1
  v_mfma_f32_16x16x32_bf16 v[96:99], a[32:35], v[50:53], v[96:99]
  v_and_b32_dpp v54, v72, v16 row_shl:2 row_mask:0xf bank_mask:0xf bound_ctrl:0
  v_and_b32 v55, v72, v17
  v_and_b32_dpp v56, v72, v18 row_shr:2 row_mask:0xf bank_mask:0xf bound_ctrl:0
  v_and_b32_dpp v57, v72, v19 row_shr:4 row_mask:0xf bank_mask:0xf bound_ctrl:0
  s_nop 1
  v_mfma_f32_16x16x32_bf16 v[100:103], a[32:35], v[54:57], v[100:103]
  v_and_b32_dpp v50, v72, v16 row_shl:4 row_mask:0xf bank_mask:0xf bound_ctrl:0
  v_and_b32_dpp v51, v72, v17 row_shl:2 row_mask:0xf bank_mask:0xf bound_ctrl:0
  v_and_b32 v52, v72, v18
  v_and_b32_dpp v53, v72, v19 row_shr:2 row_mask:0xf bank_mask:0xf bound_ctrl:0
  s_nop 1
  v_mfma_f32_16x16x32_bf16 v[104:107], a[32:35], v[50:53], v[104:107]
  v_and_b32_dpp v54, v72, v16 row_shl:6 row_mask:0xf bank_mask:0xf bound_ctrl:0
  v_and_b32_dpp v55, v72, v17 row_shl:4 row_mask:0xf bank_mask:0xf bound_ctrl:0
  v_and_b32_dpp v56, v72, v18 row_shl:2 row_mask:0xf bank_mask:0xf bound_ctrl:0
  v_and_b32 v57, v72, v19
  s_nop 1
  v_mfma_f32_16x16x32_bf16 v[108:111], a[32:35], v[54:57], v[108:111]
  v_and_b32 v50, v73, v16
  v_and_b32_dpp v51, v73, v17 row_shr:2 row_mask:0xf bank_mask:0xf bound_ctrl:0
  v_and_b32_dpp v52, v73, v18 row_shr:4 row_mask:0xf bank_mask:0xf bound_ctrl:0
  v_and_b32_dpp v53, v73, v19 row_shr:6 row_mask:0xf bank_mask:0xf bound_ctrl:0
  s_nop 1
  v_mfma_f32_16x16x32_bf16 v[96:99], a[36:39], v[50:53], v[96:99]
  v_and_b32_dpp v54, v73, v16 row_shl:2 row_mask:0xf bank_mask:0xf bound_ctrl:0
  v_and_b32 v55, v73, v17
  v_and_b32_dpp v56, v73, v18 row_shr:2 row_mask:0xf bank_mask:0xf bound_ctrl:0
  v_and_b32_dpp v57, v73, v19 row_shr:4 row_mask:0xf bank_mask:0xf bound_ctrl:0
  s_nop 1
  v_mfma_f32_16x16x32_bf16 v[100:103], a[36:39], v[54:57], v[100:103]
  v_and_b32_dpp v50, v73, v16 row_shl:4 row_mask:0xf bank_mask:0xf bound_ctrl:0
  v_and_b32_dpp v51, v73, v17 row_shl:2 row_mask:0xf bank_mask:0xf bound_ctrl:0
  v_and_b32 v52, v73, v18
  v_and_b32_dpp v53, v73, v19 row_shr:2 row_mask:0xf bank_mask:0xf bound_ctrl:0
  s_nop 1
  v_mfma_f32_16x16x32_bf16 v[104:107], a[36:39], v[50:53], v[104:107]
  v_and_b32_dpp v54, v73, v16 row_shl:6 row_mask:0xf bank_mask:0xf bound_ctrl:0
  v_and_b32_dpp v55, v73, v17 row_shl:4 row_mask:0xf bank_mask:0xf bound_ctrl:0
  v_and_b32_dpp v56, v73, v18 row_shl:2 row_mask:0xf bank_mask:0xf bound_ctrl:0
  v_and_b32 v57, v73, v19
  s_nop 1
  v_mfma_f32_16x16x32_bf16 v[108:111], a[36:39], v[54:57], v[108:111]
  v_and_b32 v50, v74, v16
  v_and_b32_dpp v51, v74, v17 row_shr:2 row_mask:0xf bank_mask:0xf bound_ctrl:0
  v_and_b32_dpp v52, v74, v18 row_shr:4 row_mask:0xf bank_mask:0xf bound_ctrl:0
  v_and_b32_dpp v53, v74, v19 row_shr:6 row_mask:0xf bank_mask:0xf bound_ctrl:0
  s_nop 1
  v_mfma_f32_16x16x32_bf16 v[96:99], a[40:43], v[50:53], v[96:99]
  v_and_b32_dpp v54, v74, v16 row_shl:2 row_mask:0xf bank_mask:0xf bound_ctrl:0
  v_and_b32 v55, v74, v17
  v_and_b32_dpp v56, v74, v18 row_shr:2 row_mask:0xf bank_mask:0xf bound_ctrl:0
  v_and_b32_dpp v57, v74, v19 row_shr:4 row_mask:0xf bank_mask:0xf bound_ctrl:0
  s_nop 1
  v_mfma_f32_16x16x32_bf16 v[100:103], a[40:43], v[54:57], v[100:103]
  v_and_b32_dpp v50, v74, v16 row_shl:4 row_mask:0xf bank_mask:0xf bound_ctrl:0
  v_and_b32_dpp v51, v74, v17 row_shl:2 row_mask:0xf bank_mask:0xf bound_ctrl:0
  v_and_b32 v52, v74, v18
  v_and_b32_dpp v53, v74, v19 row_shr:2 row_mask:0xf bank_mask:0xf bound_ctrl:0
  s_nop 1
  v_mfma_f32_16x16x32_bf16 v[104:107], a[40:43], v[50:53], v[104:107]
  v_and_b32_dpp v54, v74, v16 row_shl:6 row_mask:0xf bank_mask:0xf bound_ctrl:0
  v_and_b32_dpp v55, v74, v17 row_shl:4 row_mask:0xf bank_mask:0xf bound_ctrl:0
  v_and_b32_dpp v56, v74, v18 row_shl:2 row_mask:0xf bank_mask:0xf bound_ctrl:0
  v_and_b32 v57, v74, v19
  s_nop 1
  v_mfma_f32_16x16x32_bf16 v[108:111], a[40:43], v[54:57], v[108:111]
  v_and_b32 v50, v75, v16
  v_and_b32_dpp v51, v75, v17 row_shr:2 row_mask:0xf bank_mask:0xf bound_ctrl:0
  v_and_b32_dpp v52, v75, v18 row_shr:4 row_mask:0xf bank_mask:0xf bound_ctrl:0
  v_and_b32_dpp v53, v75, v19 row_shr:6 row_mask:0xf bank_mask:0xf bound_ctrl:0
  s_nop 1
  v_mfma_f32_16x16x32_bf16 v[96:99], a[44:47], v[50:53], v[96:99]
  v_and_b32_dpp v54, v75, v16 row_shl:2 row_mask:0xf bank_mask:0xf bound_ctrl:0
  v_and_b32 v55, v75, v17
  v_and_b32_dpp v56, v75, v18 row_shr:2 row_mask:0xf bank_mask:0xf bound_ctrl:0
  v_and_b32_dpp v57, v75, v19 row_shr:4 row_mask:0xf bank_mask:0xf bound_ctrl:0
  s_nop 1
  v_mfma_f32_16x16x32_bf16 v[100:103], a[44:47], v[54:57], v[100:103]
  v_and_b32_dpp v50, v75, v16 row_shl:4 row_mask:0xf bank_mask:0xf bound_ctrl:0
  v_and_b32_dpp v51, v75, v17 row_shl:2 row_mask:0xf bank_mask:0xf bound_ctrl:0
  v_and_b32 v52, v75, v18
  v_and_b32_dpp v53, v75, v19 row_shr:2 row_mask:0xf bank_mask:0xf bound_ctrl:0
  s_nop 1
  v_mfma_f32_16x16x32_bf16 v[104:107], a[44:47], v[50:53], v[104:107]
  v_and_b32_dpp v54, v75, v16 row_shl:6 row_mask:0xf bank_mask:0xf bound_ctrl:0
  v_and_b32_dpp v55, v75, v17 row_shl:4 row_mask:0xf bank_mask:0xf bound_ctrl:0
  v_and_b32_dpp v56, v75, v18 row_shl:2 row_mask:0xf bank_mask:0xf bound_ctrl:0
  v_and_b32 v57, v75, v19
  s_nop 1
  v_mfma_f32_16x16x32_bf16 v[108:111], a[44:47], v[54:57], v[108:111]
  v_and_b32 v50, v76, v16
  v_and_b32_dpp v51, v76, v17 row_shr:2 row_mask:0xf bank_mask:0xf bound_ctrl:0
  v_and_b32_dpp v52, v76, v18 row_shr:4 row_mask:0xf bank_mask:0xf bound_ctrl:0
  v_and_b32_dpp v53, v76, v19 row_shr:6 row_mask:0xf bank_mask:0xf bound_ctrl:0
  s_nop 1
  v_mfma_f32_16x16x32_bf16 v[96:99], a[48:51], v[50:53], v[96:99]
  v_and_b32_dpp v54, v76, v16 row_shl:2 row_mask:0xf bank_mask:0xf bound_ctrl:0
  v_and_b32 v55, v76, v17
  v_and_b32_dpp v56, v76, v18 row_shr:2 row_mask:0xf bank_mask:0xf bound_ctrl:0
  v_and_b32_dpp v57, v76, v19 row_shr:4 row_mask:0xf bank_mask:0xf bound_ctrl:0
  s_nop 1
  v_mfma_f32_16x16x32_bf16 v[100:103], a[48:51], v[54:57], v[100:103]
  v_and_b32_dpp v50, v76, v16 row_shl:4 row_mask:0xf bank_mask:0xf bound_ctrl:0
  v_and_b32_dpp v51, v76, v17 row_shl:2 row_mask:0xf bank_mask:0xf bound_ctrl:0
  v_and_b32 v52, v76, v18
  v_and_b32_dpp v53, v76, v19 row_shr:2 row_mask:0xf bank_mask:0xf bound_ctrl:0
  s_nop 1
  v_mfma_f32_16x16x32_bf16 v[104:107], a[48:51], v[50:53], v[104:107]
  v_and_b32_dpp v54, v76, v16 row_shl:6 row_mask:0xf bank_mask:0xf bound_ctrl:0
  v_and_b32_dpp v55, v76, v17 row_shl:4 row_mask:0xf bank_mask:0xf bound_ctrl:0
  v_and_b32_dpp v56, v76, v18 row_shl:2 row_mask:0xf bank_mask:0xf bound_ctrl:0
  v_and_b32 v57, v76, v19
  s_nop 1
  v_mfma_f32_16x16x32_bf16 v[108:111], a[48:51], v[54:57], v[108:111]
  v_and_b32 v50, v77, v16
  v_and_b32_dpp v51, v77, v17 row_shr:2 row_mask:0xf bank_mask:0xf bound_ctrl:0
  v_and_b32_dpp v52, v77, v18 row_shr:4 row_mask:0xf bank_mask:0xf bound_ctrl:0
  v_and_b32_dpp v53, v77, v19 row_shr:6 row_mask:0xf bank_mask:0xf bound_ctrl:0
  s_nop 1
  v_mfma_f32_16x16x32_bf16 v[96:99], a[52:55], v[50:53], v[96:99]
  v_and_b32_dpp v54, v77, v16 row_shl:2 row_mask:0xf bank_mask:0xf bound_ctrl:0
  v_and_b32 v55, v77, v17
  v_and_b32_dpp v56, v77, v18 row_shr:2 row_mask:0xf bank_mask:0xf bound_ctrl:0
  v_and_b32_dpp v57, v77, v19 row_shr:4 row_mask:0xf bank_mask:0xf bound_ctrl:0
  s_nop 1
  v_mfma_f32_16x16x32_bf16 v[100:103], a[52:55], v[54:57], v[100:103]
  v_and_b32_dpp v50, v77, v16 row_shl:4 row_mask:0xf bank_mask:0xf bound_ctrl:0
  v_and_b32_dpp v51, v77, v17 row_shl:2 row_mask:0xf bank_mask:0xf bound_ctrl:0
  v_and_b32 v52, v77, v18
  v_and_b32_dpp v53, v77, v19 row_shr:2 row_mask:0xf bank_mask:0xf bound_ctrl:0
  s_nop 1
  v_mfma_f32_16x16x32_bf16 v[104:107], a[52:55], v[50:53], v[104:107]
  v_and_b32_dpp v54, v77, v16 row_shl:6 row_mask:0xf bank_mask:0xf bound_ctrl:0
  v_and_b32_dpp v55, v77, v17 row_shl:4 row_mask:0xf bank_mask:0xf bound_ctrl:0
  v_and_b32_dpp v56, v77, v18 row_shl:2 row_mask:0xf bank_mask:0xf bound_ctrl:0
  v_and_b32 v57, v77, v19
  s_nop 1
  v_mfma_f32_16x16x32_bf16 v[108:111], a[52:55], v[54:57], v[108:111]
  v_and_b32 v50, v78, v16
  v_and_b32_dpp v51, v78, v17 row_shr:2 row_mask:0xf bank_mask:0xf bound_ctrl:0
  v_and_b32_dpp v52, v78, v18 row_shr:4 row_mask:0xf bank_mask:0xf bound_ctrl:0
  v_and_b32_dpp v53, v78, v19 row_shr:6 row_mask:0xf bank_mask:0xf bound_ctrl:0
  s_nop 1
  v_mfma_f32_16x16x32_bf16 v[96:99], a[56:59], v[50:53], v[96:99]
  v_and_b32_dpp v54, v78, v16 row_shl:2 row_mask:0xf bank_mask:0xf bound_ctrl:0
  v_and_b32 v55, v78, v17
  v_and_b32_dpp v56, v78, v18 row_shr:2 row_mask:0xf bank_mask:0xf bound_ctrl:0
  v_and_b32_dpp v57, v78, v19 row_shr:4 row_mask:0xf bank_mask:0xf bound_ctrl:0
  s_nop 1
  v_mfma_f32_16x16x32_bf16 v[100:103], a[56:59], v[54:57], v[100:103]
  v_and_b32_dpp v50, v78, v16 row_shl:4 row_mask:0xf bank_mask:0xf bound_ctrl:0
  v_and_b32_dpp v51, v78, v17 row_shl:2 row_mask:0xf bank_mask:0xf bound_ctrl:0
  v_and_b32 v52, v78, v18
  v_and_b32_dpp v53, v78, v19 row_shr:2 row_mask:0xf bank_mask:0xf bound_ctrl:0
  s_nop 1
  v_mfma_f32_16x16x32_bf16 v[104:107], a[56:59], v[50:53], v[104:107]
  v_and_b32_dpp v54, v78, v16 row_shl:6 row_mask:0xf bank_mask:0xf bound_ctrl:0
  v_and_b32_dpp v55, v78, v17 row_shl:4 row_mask:0xf bank_mask:0xf bound_ctrl:0
  v_and_b32_dpp v56, v78, v18 row_shl:2 row_mask:0xf bank_mask:0xf bound_ctrl:0
  v_and_b32 v57, v78, v19
  s_nop 1
  v_mfma_f32_16x16x32_bf16 v[108:111], a[56:59], v[54:57], v[108:111]
  v_and_b32 v50, v79, v16
  v_and_b32_dpp v51, v79, v17 row_shr:2 row_mask:0xf bank_mask:0xf bound_ctrl:0
  v_and_b32_dpp v52, v79, v18 row_shr:4 row_mask:0xf bank_mask:0xf bound_ctrl:0
  v_and_b32_dpp v53, v79, v19 row_shr:6 row_mask:0xf bank_mask:0xf bound_ctrl:0
  s_nop 1
  v_mfma_f32_16x16x32_bf16 v[96:99], a[60:63], v[50:53], v[96:99]
  v_and_b32_dpp v54, v79, v16 row_shl:2 row_mask:0xf bank_mask:0xf bound_ctrl:0
  v_and_b32 v55, v79, v17
  v_and_b32_dpp v56, v79, v18 row_shr:2 row_mask:0xf bank_mask:0xf bound_ctrl:0
  v_and_b32_dpp v57, v79, v19 row_shr:4 row_mask:0xf bank_mask:0xf bound_ctrl:0
  s_nop 1
  v_mfma_f32_16x16x32_bf16 v[100:103], a[60:63], v[54:57], v[100:103]
  v_and_b32_dpp v50, v79, v16 row_shl:4 row_mask:0xf bank_mask:0xf bound_ctrl:0
  v_and_b32_dpp v51, v79, v17 row_shl:2 row_mask:0xf bank_mask:0xf bound_ctrl:0
  v_and_b32 v52, v79, v18
  v_and_b32_dpp v53, v79, v19 row_shr:2 row_mask:0xf bank_mask:0xf bound_ctrl:0
  s_nop 1
  v_mfma_f32_16x16x32_bf16 v[104:107], a[60:63], v[50:53], v[104:107]
  v_and_b32_dpp v54, v79, v16 row_shl:6 row_mask:0xf bank_mask:0xf bound_ctrl:0
  v_and_b32_dpp v55, v79, v17 row_shl:4 row_mask:0xf bank_mask:0xf bound_ctrl:0
  v_and_b32_dpp v56, v79, v18 row_shl:2 row_mask:0xf bank_mask:0xf bound_ctrl:0
  v_and_b32 v57, v79, v19
  s_nop 1
  v_mfma_f32_16x16x32_bf16 v[108:111], a[60:63], v[54:57], v[108:111]
  v_and_b32 v50, v80, v16
  v_and_b32_dpp v51, v80, v17 row_shr:2 row_mask:0xf bank_mask:0xf bound_ctrl:0
  v_and_b32_dpp v52, v80, v18 row_shr:4 row_mask:0xf bank_mask:0xf bound_ctrl:0
  v_and_b32_dpp v53, v80, v19 row_shr:6 row_mask:0xf bank_mask:0xf bound_ctrl:0
  s_nop 1
  v_mfma_f32_16x16x32_bf16 v[96:99], a[64:67], v[50:53], v[96:99]
  v_and_b32_dpp v54, v80, v16 row_shl:2 row_mask:0xf bank_mask:0xf bound_ctrl:0
  v_and_b32 v55, v80, v17
  v_and_b32_dpp v56, v80, v18 row_shr:2 row_mask:0xf bank_mask:0xf bound_ctrl:0
  v_and_b32_dpp v57, v80, v19 row_shr:4 row_mask:0xf bank_mask:0xf bound_ctrl:0
  s_nop 1
  v_mfma_f32_16x16x32_bf16 v[100:103], a[64:67], v[54:57], v[100:103]
  v_and_b32_dpp v50, v80, v16 row_shl:4 row_mask:0xf bank_mask:0xf bound_ctrl:0
  v_and_b32_dpp v51, v80, v17 row_shl:2 row_mask:0xf bank_mask:0xf bound_ctrl:0
  v_and_b32 v52, v80, v18
  v_and_b32_dpp v53, v80, v19 row_shr:2 row_mask:0xf bank_mask:0xf bound_ctrl:0
  s_nop 1
  v_mfma_f32_16x16x32_bf16 v[104:107], a[64:67], v[50:53], v[104:107]
  v_and_b32_dpp v54, v80, v16 row_shl:6 row_mask:0xf bank_mask:0xf bound_ctrl:0
  v_and_b32_dpp v55, v80, v17 row_shl:4 row_mask:0xf bank_mask:0xf bound_ctrl:0
  v_and_b32_dpp v56, v80, v18 row_shl:2 row_mask:0xf bank_mask:0xf bound_ctrl:0
  v_and_b32 v57, v80, v19
  s_nop 1
  v_mfma_f32_16x16x32_bf16 v[108:111], a[64:67], v[54:57], v[108:111]
  v_and_b32 v50, v81, v16
  v_and_b32_dpp v51, v81, v17 row_shr:2 row_mask:0xf bank_mask:0xf bound_ctrl:0
  v_and_b32_dpp v52, v81, v18 row_shr:4 row_mask:0xf bank_mask:0xf bound_ctrl:0
  v_and_b32_dpp v53, v81, v19 row_shr:6 row_mask:0xf bank_mask:0xf bound_ctrl:0
  s_nop 1
  v_mfma_f32_16x16x32_bf16 v[96:99], a[68:71], v[50:53], v[96:99]
  v_and_b32_dpp v54, v81, v16 row_shl:2 row_mask:0xf bank_mask:0xf bound_ctrl:0
  v_and_b32 v55, v81, v17
  v_and_b32_dpp v56, v81, v18 row_shr:2 row_mask:0xf bank_mask:0xf bound_ctrl:0
  v_and_b32_dpp v57, v81, v19 row_shr:4 row_mask:0xf bank_mask:0xf bound_ctrl:0
  s_nop 1
  v_mfma_f32_16x16x32_bf16 v[100:103], a[68:71], v[54:57], v[100:103]
  v_and_b32_dpp v50, v81, v16 row_shl:4 row_mask:0xf bank_mask:0xf bound_ctrl:0
  v_and_b32_dpp v51, v81, v17 row_shl:2 row_mask:0xf bank_mask:0xf bound_ctrl:0
  v_and_b32 v52, v81, v18
  v_and_b32_dpp v53, v81, v19 row_shr:2 row_mask:0xf bank_mask:0xf bound_ctrl:0
  s_nop 1
  v_mfma_f32_16x16x32_bf16 v[104:107], a[68:71], v[50:53], v[104:107]
  v_and_b32_dpp v54, v81, v16 row_shl:6 row_mask:0xf bank_mask:0xf bound_ctrl:0
  v_and_b32_dpp v55, v81, v17 row_shl:4 row_mask:0xf bank_mask:0xf bound_ctrl:0
  v_and_b32_dpp v56, v81, v18 row_shl:2 row_mask:0xf bank_mask:0xf bound_ctrl:0
  v_and_b32 v57, v81, v19
  s_nop 1
  v_mfma_f32_16x16x32_bf16 v[108:111], a[68:71], v[54:57], v[108:111]
  v_and_b32 v50, v82, v16
  v_and_b32_dpp v51, v82, v17 row_shr:2 row_mask:0xf bank_mask:0xf bound_ctrl:0
  v_and_b32_dpp v52, v82, v18 row_shr:4 row_mask:0xf bank_mask:0xf bound_ctrl:0
  v_and_b32_dpp v53, v82, v19 row_shr:6 row_mask:0xf bank_mask:0xf bound_ctrl:0
  s_nop 1
  v_mfma_f32_16x16x32_bf16 v[96:99], a[72:75], v[50:53], v[96:99]
  v_and_b32_dpp v54, v82, v16 row_shl:2 row_mask:0xf bank_mask:0xf bound_ctrl:0
  v_and_b32 v55, v82, v17
  v_and_b32_dpp v56, v82, v18 row_shr:2 row_mask:0xf bank_mask:0xf bound_ctrl:0
  v_and_b32_dpp v57, v82, v19 row_shr:4 row_mask:0xf bank_mask:0xf bound_ctrl:0
  s_nop 1
  v_mfma_f32_16x16x32_bf16 v[100:103], a[72:75], v[54:57], v[100:103]
  v_and_b32_dpp v50, v82, v16 row_shl:4 row_mask:0xf bank_mask:0xf bound_ctrl:0
  v_and_b32_dpp v51, v82, v17 row_shl:2 row_mask:0xf bank_mask:0xf bound_ctrl:0
  v_and_b32 v52, v82, v18
  v_and_b32_dpp v53, v82, v19 row_shr:2 row_mask:0xf bank_mask:0xf bound_ctrl:0
  s_nop 1
  v_mfma_f32_16x16x32_bf16 v[104:107], a[72:75], v[50:53], v[104:107]
  v_and_b32_dpp v54, v82, v16 row_shl:6 row_mask:0xf bank_mask:0xf bound_ctrl:0
  v_and_b32_dpp v55, v82, v17 row_shl:4 row_mask:0xf bank_mask:0xf bound_ctrl:0
  v_and_b32_dpp v56, v82, v18 row_shl:2 row_mask:0xf bank_mask:0xf bound_ctrl:0
  v_and_b32 v57, v82, v19
  s_nop 1
  v_mfma_f32_16x16x32_bf16 v[108:111], a[72:75], v[54:57], v[108:111]
  v_and_b32 v50, v83, v16
  v_and_b32_dpp v51, v83, v17 row_shr:2 row_mask:0xf bank_mask:0xf bound_ctrl:0
  v_and_b32_dpp v52, v83, v18 row_shr:4 row_mask:0xf bank_mask:0xf bound_ctrl:0
  v_and_b32_dpp v53, v83, v19 row_shr:6 row_mask:0xf bank_mask:0xf bound_ctrl:0
  s_nop 1
  v_mfma_f32_16x16x32_bf16 v[96:99], a[76:79], v[50:53], v[96:99]
  v_and_b32_dpp v54, v83, v16 row_shl:2 row_mask:0xf bank_mask:0xf bound_ctrl:0
  v_and_b32 v55, v83, v17
  v_and_b32_dpp v56, v83, v18 row_shr:2 row_mask:0xf bank_mask:0xf bound_ctrl:0
  v_and_b32_dpp v57, v83, v19 row_shr:4 row_mask:0xf bank_mask:0xf bound_ctrl:0
  s_nop 1
  v_mfma_f32_16x16x32_bf16 v[100:103], a[76:79], v[54:57], v[100:103]
  v_and_b32_dpp v50, v83, v16 row_shl:4 row_mask:0xf bank_mask:0xf bound_ctrl:0
  v_and_b32_dpp v51, v83, v17 row_shl:2 row_mask:0xf bank_mask:0xf bound_ctrl:0
  v_and_b32 v52, v83, v18
  v_and_b32_dpp v53, v83, v19 row_shr:2 row_mask:0xf bank_mask:0xf bound_ctrl:0
  s_nop 1
  v_mfma_f32_16x16x32_bf16 v[104:107], a[76:79], v[50:53], v[104:107]
  v_and_b32_dpp v54, v83, v16 row_shl:6 row_mask:0xf bank_mask:0xf bound_ctrl:0
  v_and_b32_dpp v55, v83, v17 row_shl:4 row_mask:0xf bank_mask:0xf bound_ctrl:0
  v_and_b32_dpp v56, v83, v18 row_shl:2 row_mask:0xf bank_mask:0xf bound_ctrl:0
  v_and_b32 v57, v83, v19
  s_nop 1
  v_mfma_f32_16x16x32_bf16 v[108:111], a[76:79], v[54:57], v[108:111]
  v_and_b32 v50, v84, v16
  v_and_b32_dpp v51, v84, v17 row_shr:2 row_mask:0xf bank_mask:0xf bound_ctrl:0
  v_and_b32_dpp v52, v84, v18 row_shr:4 row_mask:0xf bank_mask:0xf bound_ctrl:0
  v_and_b32_dpp v53, v84, v19 row_shr:6 row_mask:0xf bank_mask:0xf bound_ctrl:0
  s_nop 1
  v_mfma_f32_16x16x32_bf16 v[96:99], a[80:83], v[50:53], v[96:99]
  v_and_b32_dpp v54, v84, v16 row_shl:2 row_mask:0xf bank_mask:0xf bound_ctrl:0
  v_and_b32 v55, v84, v17
  v_and_b32_dpp v56, v84, v18 row_shr:2 row_mask:0xf bank_mask:0xf bound_ctrl:0
  v_and_b32_dpp v57, v84, v19 row_shr:4 row_mask:0xf bank_mask:0xf bound_ctrl:0
  s_nop 1
  v_mfma_f32_16x16x32_bf16 v[100:103], a[80:83], v[54:57], v[100:103]
  v_and_b32_dpp v50, v84, v16 row_shl:4 row_mask:0xf bank_mask:0xf bound_ctrl:0
  v_and_b32_dpp v51, v84, v17 row_shl:2 row_mask:0xf bank_mask:0xf bound_ctrl:0
  v_and_b32 v52, v84, v18
  v_and_b32_dpp v53, v84, v19 row_shr:2 row_mask:0xf bank_mask:0xf bound_ctrl:0
  s_nop 1
  v_mfma_f32_16x16x32_bf16 v[104:107], a[80:83], v[50:53], v[104:107]
  v_and_b32_dpp v54, v84, v16 row_shl:6 row_mask:0xf bank_mask:0xf bound_ctrl:0
  v_and_b32_dpp v55, v84, v17 row_shl:4 row_mask:0xf bank_mask:0xf bound_ctrl:0
  v_and_b32_dpp v56, v84, v18 row_shl:2 row_mask:0xf bank_mask:0xf bound_ctrl:0
  v_and_b32 v57, v84, v19
  s_nop 1
  v_mfma_f32_16x16x32_bf16 v[108:111], a[80:83], v[54:57], v[108:111]
  v_and_b32 v50, v85, v16
  v_and_b32_dpp v51, v85, v17 row_shr:2 row_mask:0xf bank_mask:0xf bound_ctrl:0
  v_and_b32_dpp v52, v85, v18 row_shr:4 row_mask:0xf bank_mask:0xf bound_ctrl:0
  v_and_b32_dpp v53, v85, v19 row_shr:6 row_mask:0xf bank_mask:0xf bound_ctrl:0
  s_nop 1
  v_mfma_f32_16x16x32_bf16 v[96:99], a[84:87], v[50:53], v[96:99]
  v_and_b32_dpp v54, v85, v16 row_shl:2 row_mask:0xf bank_mask:0xf bound_ctrl:0
  v_and_b32 v55, v85, v17
  v_and_b32_dpp v56, v85, v18 row_shr:2 row_mask:0xf bank_mask:0xf bound_ctrl:0
  v_and_b32_dpp v57, v85, v19 row_shr:4 row_mask:0xf bank_mask:0xf bound_ctrl:0
  s_nop 1
  v_mfma_f32_16x16x32_bf16 v[100:103], a[84:87], v[54:57], v[100:103]
  v_and_b32_dpp v50, v85, v16 row_shl:4 row_mask:0xf bank_mask:0xf bound_ctrl:0
  v_and_b32_dpp v51, v85, v17 row_shl:2 row_mask:0xf bank_mask:0xf bound_ctrl:0
  v_and_b32 v52, v85, v18
  v_and_b32_dpp v53, v85, v19 row_shr:2 row_mask:0xf bank_mask:0xf bound_ctrl:0
  s_nop 1
  v_mfma_f32_16x16x32_bf16 v[104:107], a[84:87], v[50:53], v[104:107]
  v_and_b32_dpp v54, v85, v16 row_shl:6 row_mask:0xf bank_mask:0xf bound_ctrl:0
  v_and_b32_dpp v55, v85, v17 row_shl:4 row_mask:0xf bank_mask:0xf bound_ctrl:0
  v_and_b32_dpp v56, v85, v18 row_shl:2 row_mask:0xf bank_mask:0xf bound_ctrl:0
  v_and_b32 v57, v85, v19
  s_nop 1
  v_mfma_f32_16x16x32_bf16 v[108:111], a[84:87], v[54:57], v[108:111]
  v_and_b32 v50, v86, v16
  v_and_b32_dpp v51, v86, v17 row_shr:2 row_mask:0xf bank_mask:0xf bound_ctrl:0
  v_and_b32_dpp v52, v86, v18 row_shr:4 row_mask:0xf bank_mask:0xf bound_ctrl:0
  v_and_b32_dpp v53, v86, v19 row_shr:6 row_mask:0xf bank_mask:0xf bound_ctrl:0
  s_nop 1
  v_mfma_f32_16x16x32_bf16 v[96:99], a[88:91], v[50:53], v[96:99]
  v_and_b32_dpp v54, v86, v16 row_shl:2 row_mask:0xf bank_mask:0xf bound_ctrl:0
  v_and_b32 v55, v86, v17
  v_and_b32_dpp v56, v86, v18 row_shr:2 row_mask:0xf bank_mask:0xf bound_ctrl:0
  v_and_b32_dpp v57, v86, v19 row_shr:4 row_mask:0xf bank_mask:0xf bound_ctrl:0
  s_nop 1
  v_mfma_f32_16x16x32_bf16 v[100:103], a[88:91], v[54:57], v[100:103]
  v_and_b32_dpp v50, v86, v16 row_shl:4 row_mask:0xf bank_mask:0xf bound_ctrl:0
  v_and_b32_dpp v51, v86, v17 row_shl:2 row_mask:0xf bank_mask:0xf bound_ctrl:0
  v_and_b32 v52, v86, v18
  v_and_b32_dpp v53, v86, v19 row_shr:2 row_mask:0xf bank_mask:0xf bound_ctrl:0
  s_nop 1
  v_mfma_f32_16x16x32_bf16 v[104:107], a[88:91], v[50:53], v[104:107]
  v_and_b32_dpp v54, v86, v16 row_shl:6 row_mask:0xf bank_mask:0xf bound_ctrl:0
  v_and_b32_dpp v55, v86, v17 row_shl:4 row_mask:0xf bank_mask:0xf bound_ctrl:0
  v_and_b32_dpp v56, v86, v18 row_shl:2 row_mask:0xf bank_mask:0xf bound_ctrl:0
  v_and_b32 v57, v86, v19
  s_nop 1
  v_mfma_f32_16x16x32_bf16 v[108:111], a[88:91], v[54:57], v[108:111]
  v_and_b32 v50, v87, v16
  v_and_b32_dpp v51, v87, v17 row_shr:2 row_mask:0xf bank_mask:0xf bound_ctrl:0
  v_and_b32_dpp v52, v87, v18 row_shr:4 row_mask:0xf bank_mask:0xf bound_ctrl:0
  v_and_b32_dpp v53, v87, v19 row_shr:6 row_mask:0xf bank_mask:0xf bound_ctrl:0
  s_nop 1
  v_mfma_f32_16x16x32_bf16 v[96:99], a[92:95], v[50:53], v[96:99]
  v_and_b32_dpp v54, v87, v16 row_shl:2 row_mask:0xf bank_mask:0xf bound_ctrl:0
  v_and_b32 v55, v87, v17
  v_and_b32_dpp v56, v87, v18 row_shr:2 row_mask:0xf bank_mask:0xf bound_ctrl:0
  v_and_b32_dpp v57, v87, v19 row_shr:4 row_mask:0xf bank_mask:0xf bound_ctrl:0
  s_nop 1
  v_mfma_f32_16x16x32_bf16 v[100:103], a[92:95], v[54:57], v[100:103]
  v_and_b32_dpp v50, v87, v16 row_shl:4 row_mask:0xf bank_mask:0xf bound_ctrl:0
  v_and_b32_dpp v51, v87, v17 row_shl:2 row_mask:0xf bank_mask:0xf bound_ctrl:0
  v_and_b32 v52, v87, v18
  v_and_b32_dpp v53, v87, v19 row_shr:2 row_mask:0xf bank_mask:0xf bound_ctrl:0
  s_nop 1
  v_mfma_f32_16x16x32_bf16 v[104:107], a[92:95], v[50:53], v[104:107]
  v_and_b32_dpp v54, v87, v16 row_shl:6 row_mask:0xf bank_mask:0xf bound_ctrl:0
  v_and_b32_dpp v55, v87, v17 row_shl:4 row_mask:0xf bank_mask:0xf bound_ctrl:0
  v_and_b32_dpp v56, v87, v18 row_shl:2 row_mask:0xf bank_mask:0xf bound_ctrl:0
  v_and_b32 v57, v87, v19
  s_nop 1
  v_mfma_f32_16x16x32_bf16 v[108:111], a[92:95], v[54:57], v[108:111]
  v_and_b32 v50, v88, v16
  v_and_b32_dpp v51, v88, v17 row_shr:2 row_mask:0xf bank_mask:0xf bound_ctrl:0
  v_and_b32_dpp v52, v88, v18 row_shr:4 row_mask:0xf bank_mask:0xf bound_ctrl:0
  v_and_b32_dpp v53, v88, v19 row_shr:6 row_mask:0xf bank_mask:0xf bound_ctrl:0
  s_nop 1
  v_mfma_f32_16x16x32_bf16 v[96:99], a[96:99], v[50:53], v[96:99]
  v_and_b32_dpp v54, v88, v16 row_shl:2 row_mask:0xf bank_mask:0xf bound_ctrl:0
  v_and_b32 v55, v88, v17
  v_and_b32_dpp v56, v88, v18 row_shr:2 row_mask:0xf bank_mask:0xf bound_ctrl:0
  v_and_b32_dpp v57, v88, v19 row_shr:4 row_mask:0xf bank_mask:0xf bound_ctrl:0
  s_nop 1
  v_mfma_f32_16x16x32_bf16 v[100:103], a[96:99], v[54:57], v[100:103]
  v_and_b32_dpp v50, v88, v16 row_shl:4 row_mask:0xf bank_mask:0xf bound_ctrl:0
  v_and_b32_dpp v51, v88, v17 row_shl:2 row_mask:0xf bank_mask:0xf bound_ctrl:0
  v_and_b32 v52, v88, v18
  v_and_b32_dpp v53, v88, v19 row_shr:2 row_mask:0xf bank_mask:0xf bound_ctrl:0
  s_nop 1
  v_mfma_f32_16x16x32_bf16 v[104:107], a[96:99], v[50:53], v[104:107]
  v_and_b32_dpp v54, v88, v16 row_shl:6 row_mask:0xf bank_mask:0xf bound_ctrl:0
  v_and_b32_dpp v55, v88, v17 row_shl:4 row_mask:0xf bank_mask:0xf bound_ctrl:0
  v_and_b32_dpp v56, v88, v18 row_shl:2 row_mask:0xf bank_mask:0xf bound_ctrl:0
  v_and_b32 v57, v88, v19
  s_nop 1
  v_mfma_f32_16x16x32_bf16 v[108:111], a[96:99], v[54:57], v[108:111]
  v_and_b32 v50, v89, v16
  v_and_b32_dpp v51, v89, v17 row_shr:2 row_mask:0xf bank_mask:0xf bound_ctrl:0
  v_and_b32_dpp v52, v89, v18 row_shr:4 row_mask:0xf bank_mask:0xf bound_ctrl:0
  v_and_b32_dpp v53, v89, v19 row_shr:6 row_mask:0xf bank_mask:0xf bound_ctrl:0
  s_nop 1
  v_mfma_f32_16x16x32_bf16 v[96:99], a[100:103], v[50:53], v[96:99]
  v_and_b32_dpp v54, v89, v16 row_shl:2 row_mask:0xf bank_mask:0xf bound_ctrl:0
  v_and_b32 v55, v89, v17
  v_and_b32_dpp v56, v89, v18 row_shr:2 row_mask:0xf bank_mask:0xf bound_ctrl:0
  v_and_b32_dpp v57, v89, v19 row_shr:4 row_mask:0xf bank_mask:0xf bound_ctrl:0
  s_nop 1
  v_mfma_f32_16x16x32_bf16 v[100:103], a[100:103], v[54:57], v[100:103]
  v_and_b32_dpp v50, v89, v16 row_shl:4 row_mask:0xf bank_mask:0xf bound_ctrl:0
  v_and_b32_dpp v51, v89, v17 row_shl:2 row_mask:0xf bank_mask:0xf bound_ctrl:0
  v_and_b32 v52, v89, v18
  v_and_b32_dpp v53, v89, v19 row_shr:2 row_mask:0xf bank_mask:0xf bound_ctrl:0
  s_nop 1
  v_mfma_f32_16x16x32_bf16 v[104:107], a[100:103], v[50:53], v[104:107]
  v_and_b32_dpp v54, v89, v16 row_shl:6 row_mask:0xf bank_mask:0xf bound_ctrl:0
  v_and_b32_dpp v55, v89, v17 row_shl:4 row_mask:0xf bank_mask:0xf bound_ctrl:0
  v_and_b32_dpp v56, v89, v18 row_shl:2 row_mask:0xf bank_mask:0xf bound_ctrl:0
  v_and_b32 v57, v89, v19
  s_nop 1
  v_mfma_f32_16x16x32_bf16 v[108:111], a[100:103], v[54:57], v[108:111]
  v_and_b32 v50, v90, v16
  v_and_b32_dpp v51, v90, v17 row_shr:2 row_mask:0xf bank_mask:0xf bound_ctrl:0
  v_and_b32_dpp v52, v90, v18 row_shr:4 row_mask:0xf bank_mask:0xf bound_ctrl:0
  v_and_b32_dpp v53, v90, v19 row_shr:6 row_mask:0xf bank_mask:0xf bound_ctrl:0
  s_nop 1
  v_mfma_f32_16x16x32_bf16 v[96:99], a[104:107], v[50:53], v[96:99]
  v_and_b32_dpp v54, v90, v16 row_shl:2 row_mask:0xf bank_mask:0xf bound_ctrl:0
  v_and_b32 v55, v90, v17
  v_and_b32_dpp v56, v90, v18 row_shr:2 row_mask:0xf bank_mask:0xf bound_ctrl:0
  v_and_b32_dpp v57, v90, v19 row_shr:4 row_mask:0xf bank_mask:0xf bound_ctrl:0
  s_nop 1
  v_mfma_f32_16x16x32_bf16 v[100:103], a[104:107], v[54:57], v[100:103]
  v_and_b32_dpp v50, v90, v16 row_shl:4 row_mask:0xf bank_mask:0xf bound_ctrl:0
  v_and_b32_dpp v51, v90, v17 row_shl:2 row_mask:0xf bank_mask:0xf bound_ctrl:0
  v_and_b32 v52, v90, v18
  v_and_b32_dpp v53, v90, v19 row_shr:2 row_mask:0xf bank_mask:0xf bound_ctrl:0
  s_nop 1
  v_mfma_f32_16x16x32_bf16 v[104:107], a[104:107], v[50:53], v[104:107]
  v_and_b32_dpp v54, v90, v16 row_shl:6 row_mask:0xf bank_mask:0xf bound_ctrl:0
  v_and_b32_dpp v55, v90, v17 row_shl:4 row_mask:0xf bank_mask:0xf bound_ctrl:0
  v_and_b32_dpp v56, v90, v18 row_shl:2 row_mask:0xf bank_mask:0xf bound_ctrl:0
  v_and_b32 v57, v90, v19
  s_nop 1
  v_mfma_f32_16x16x32_bf16 v[108:111], a[104:107], v[54:57], v[108:111]
  v_and_b32 v50, v91, v16
  v_and_b32_dpp v51, v91, v17 row_shr:2 row_mask:0xf bank_mask:0xf bound_ctrl:0
  v_and_b32_dpp v52, v91, v18 row_shr:4 row_mask:0xf bank_mask:0xf bound_ctrl:0
  v_and_b32_dpp v53, v91, v19 row_shr:6 row_mask:0xf bank_mask:0xf bound_ctrl:0
  s_nop 1
  v_mfma_f32_16x16x32_bf16 v[96:99], a[108:111], v[50:53], v[96:99]
  v_and_b32_dpp v54, v91, v16 row_shl:2 row_mask:0xf bank_mask:0xf bound_ctrl:0
  v_and_b32 v55, v91, v17
  v_and_b32_dpp v56, v91, v18 row_shr:2 row_mask:0xf bank_mask:0xf bound_ctrl:0
  v_and_b32_dpp v57, v91, v19 row_shr:4 row_mask:0xf bank_mask:0xf bound_ctrl:0
  s_nop 1
  v_mfma_f32_16x16x32_bf16 v[100:103], a[108:111], v[54:57], v[100:103]
  v_and_b32_dpp v50, v91, v16 row_shl:4 row_mask:0xf bank_mask:0xf bound_ctrl:0
  v_and_b32_dpp v51, v91, v17 row_shl:2 row_mask:0xf bank_mask:0xf bound_ctrl:0
  v_and_b32 v52, v91, v18
  v_and_b32_dpp v53, v91, v19 row_shr:2 row_mask:0xf bank_mask:0xf bound_ctrl:0
  s_nop 1
  v_mfma_f32_16x16x32_bf16 v[104:107], a[108:111], v[50:53], v[104:107]
  v_and_b32_dpp v54, v91, v16 row_shl:6 row_mask:0xf bank_mask:0xf bound_ctrl:0
  v_and_b32_dpp v55, v91, v17 row_shl:4 row_mask:0xf bank_mask:0xf bound_ctrl:0
  v_and_b32_dpp v56, v91, v18 row_shl:2 row_mask:0xf bank_mask:0xf bound_ctrl:0
  v_and_b32 v57, v91, v19
  s_nop 1
  v_mfma_f32_16x16x32_bf16 v[108:111], a[108:111], v[54:57], v[108:111]
  v_and_b32 v50, v92, v16
  v_and_b32_dpp v51, v92, v17 row_shr:2 row_mask:0xf bank_mask:0xf bound_ctrl:0
  v_and_b32_dpp v52, v92, v18 row_shr:4 row_mask:0xf bank_mask:0xf bound_ctrl:0
  v_and_b32_dpp v53, v92, v19 row_shr:6 row_mask:0xf bank_mask:0xf bound_ctrl:0
  s_nop 1
  v_mfma_f32_16x16x32_bf16 v[96:99], a[112:115], v[50:53], v[96:99]
  v_and_b32_dpp v54, v92, v16 row_shl:2 row_mask:0xf bank_mask:0xf bound_ctrl:0
  v_and_b32 v55, v92, v17
  v_and_b32_dpp v56, v92, v18 row_shr:2 row_mask:0xf bank_mask:0xf bound_ctrl:0
  v_and_b32_dpp v57, v92, v19 row_shr:4 row_mask:0xf bank_mask:0xf bound_ctrl:0
  s_nop 1
  v_mfma_f32_16x16x32_bf16 v[100:103], a[112:115], v[54:57], v[100:103]
  v_and_b32_dpp v50, v92, v16 row_shl:4 row_mask:0xf bank_mask:0xf bound_ctrl:0
  v_and_b32_dpp v51, v92, v17 row_shl:2 row_mask:0xf bank_mask:0xf bound_ctrl:0
  v_and_b32 v52, v92, v18
  v_and_b32_dpp v53, v92, v19 row_shr:2 row_mask:0xf bank_mask:0xf bound_ctrl:0
  s_nop 1
  v_mfma_f32_16x16x32_bf16 v[104:107], a[112:115], v[50:53], v[104:107]
  v_and_b32_dpp v54, v92, v16 row_shl:6 row_mask:0xf bank_mask:0xf bound_ctrl:0
  v_and_b32_dpp v55, v92, v17 row_shl:4 row_mask:0xf bank_mask:0xf bound_ctrl:0
  v_and_b32_dpp v56, v92, v18 row_shl:2 row_mask:0xf bank_mask:0xf bound_ctrl:0
  v_and_b32 v57, v92, v19
  s_nop 1
  v_mfma_f32_16x16x32_bf16 v[108:111], a[112:115], v[54:57], v[108:111]
  v_and_b32 v50, v93, v16
  v_and_b32_dpp v51, v93, v17 row_shr:2 row_mask:0xf bank_mask:0xf bound_ctrl:0
  v_and_b32_dpp v52, v93, v18 row_shr:4 row_mask:0xf bank_mask:0xf bound_ctrl:0
  v_and_b32_dpp v53, v93, v19 row_shr:6 row_mask:0xf bank_mask:0xf bound_ctrl:0
  s_nop 1
  v_mfma_f32_16x16x32_bf16 v[96:99], a[116:119], v[50:53], v[96:99]
  v_and_b32_dpp v54, v93, v16 row_shl:2 row_mask:0xf bank_mask:0xf bound_ctrl:0
  v_and_b32 v55, v93, v17
  v_and_b32_dpp v56, v93, v18 row_shr:2 row_mask:0xf bank_mask:0xf bound_ctrl:0
  v_and_b32_dpp v57, v93, v19 row_shr:4 row_mask:0xf bank_mask:0xf bound_ctrl:0
  s_nop 1
  v_mfma_f32_16x16x32_bf16 v[100:103], a[116:119], v[54:57], v[100:103]
  v_and_b32_dpp v50, v93, v16 row_shl:4 row_mask:0xf bank_mask:0xf bound_ctrl:0
  v_and_b32_dpp v51, v93, v17 row_shl:2 row_mask:0xf bank_mask:0xf bound_ctrl:0
  v_and_b32 v52, v93, v18
  v_and_b32_dpp v53, v93, v19 row_shr:2 row_mask:0xf bank_mask:0xf bound_ctrl:0
  s_nop 1
  v_mfma_f32_16x16x32_bf16 v[104:107], a[116:119], v[50:53], v[104:107]
  v_and_b32_dpp v54, v93, v16 row_shl:6 row_mask:0xf bank_mask:0xf bound_ctrl:0
  v_and_b32_dpp v55, v93, v17 row_shl:4 row_mask:0xf bank_mask:0xf bound_ctrl:0
  v_and_b32_dpp v56, v93, v18 row_shl:2 row_mask:0xf bank_mask:0xf bound_ctrl:0
  v_and_b32 v57, v93, v19
  s_nop 1
  v_mfma_f32_16x16x32_bf16 v[108:111], a[116:119], v[54:57], v[108:111]
  v_and_b32 v50, v94, v16
  v_and_b32_dpp v51, v94, v17 row_shr:2 row_mask:0xf bank_mask:0xf bound_ctrl:0
  v_and_b32_dpp v52, v94, v18 row_shr:4 row_mask:0xf bank_mask:0xf bound_ctrl:0
  v_and_b32_dpp v53, v94, v19 row_shr:6 row_mask:0xf bank_mask:0xf bound_ctrl:0
  s_nop 1
  v_mfma_f32_16x16x32_bf16 v[96:99], a[120:123], v[50:53], v[96:99]
  v_and_b32_dpp v54, v94, v16 row_shl:2 row_mask:0xf bank_mask:0xf bound_ctrl:0
  v_and_b32 v55, v94, v17
  v_and_b32_dpp v56, v94, v18 row_shr:2 row_mask:0xf bank_mask:0xf bound_ctrl:0
  v_and_b32_dpp v57, v94, v19 row_shr:4 row_mask:0xf bank_mask:0xf bound_ctrl:0
  s_nop 1
  v_mfma_f32_16x16x32_bf16 v[100:103], a[120:123], v[54:57], v[100:103]
  v_and_b32_dpp v50, v94, v16 row_shl:4 row_mask:0xf bank_mask:0xf bound_ctrl:0
  v_and_b32_dpp v51, v94, v17 row_shl:2 row_mask:0xf bank_mask:0xf bound_ctrl:0
  v_and_b32 v52, v94, v18
  v_and_b32_dpp v53, v94, v19 row_shr:2 row_mask:0xf bank_mask:0xf bound_ctrl:0
  s_nop 1
  v_mfma_f32_16x16x32_bf16 v[104:107], a[120:123], v[50:53], v[104:107]
  v_and_b32_dpp v54, v94, v16 row_shl:6 row_mask:0xf bank_mask:0xf bound_ctrl:0
  v_and_b32_dpp v55, v94, v17 row_shl:4 row_mask:0xf bank_mask:0xf bound_ctrl:0
  v_and_b32_dpp v56, v94, v18 row_shl:2 row_mask:0xf bank_mask:0xf bound_ctrl:0
  v_and_b32 v57, v94, v19
  s_nop 1
  v_mfma_f32_16x16x32_bf16 v[108:111], a[120:123], v[54:57], v[108:111]
  v_and_b32 v50, v95, v16
  v_and_b32_dpp v51, v95, v17 row_shr:2 row_mask:0xf bank_mask:0xf bound_ctrl:0
  v_and_b32_dpp v52, v95, v18 row_shr:4 row_mask:0xf bank_mask:0xf bound_ctrl:0
  v_and_b32_dpp v53, v95, v19 row_shr:6 row_mask:0xf bank_mask:0xf bound_ctrl:0
  s_nop 1
  v_mfma_f32_16x16x32_bf16 v[96:99], a[124:127], v[50:53], v[96:99]
  v_and_b32_dpp v54, v95, v16 row_shl:2 row_mask:0xf bank_mask:0xf bound_ctrl:0
  v_and_b32 v55, v95, v17
  v_and_b32_dpp v56, v95, v18 row_shr:2 row_mask:0xf bank_mask:0xf bound_ctrl:0
  v_and_b32_dpp v57, v95, v19 row_shr:4 row_mask:0xf bank_mask:0xf bound_ctrl:0
  s_nop 1
  v_mfma_f32_16x16x32_bf16 v[100:103], a[124:127], v[54:57], v[100:103]
  v_and_b32_dpp v50, v95, v16 row_shl:4 row_mask:0xf bank_mask:0xf bound_ctrl:0
  v_and_b32_dpp v51, v95, v17 row_shl:2 row_mask:0xf bank_mask:0xf bound_ctrl:0
  v_and_b32 v52, v95, v18
  v_and_b32_dpp v53, v95, v19 row_shr:2 row_mask:0xf bank_mask:0xf bound_ctrl:0
  s_nop 1
  v_mfma_f32_16x16x32_bf16 v[104:107], a[124:127], v[50:53], v[104:107]
  v_and_b32_dpp v54, v95, v16 row_shl:6 row_mask:0xf bank_mask:0xf bound_ctrl:0
  v_and_b32_dpp v55, v95, v17 row_shl:4 row_mask:0xf bank_mask:0xf bound_ctrl:0
  v_and_b32_dpp v56, v95, v18 row_shl:2 row_mask:0xf bank_mask:0xf bound_ctrl:0
  v_and_b32 v57, v95, v19
  s_nop 1
  v_mfma_f32_16x16x32_bf16 v[108:111], a[124:127], v[54:57], v[108:111]
  v_rcp_f32 v7, v47
  v_log_f32 v47, v47
  s_nop 0
  v_add_f32 v46, v46, v47
  v_min_u32 v46, -2, v46
  v_mov_b32_dpp v5, v7 row_newbcast:0 row_mask:0xf bank_mask:0x3
  v_mov_b32_dpp v5, v7 row_newbcast:8 row_mask:0xf bank_mask:0xc
  v_mul_f32 v96, v96, v5
  v_mul_f32 v97, v97, v5
  v_mul_f32 v98, v98, v5
  v_mul_f32 v99, v99, v5
  v_cvt_pk_bf16_f32 v96, v96, v97
  v_cvt_pk_bf16_f32 v97, v98, v99
  v_mov_b32_dpp v5, v7 row_newbcast:2 row_mask:0xf bank_mask:0x3
  v_mov_b32_dpp v5, v7 row_newbcast:10 row_mask:0xf bank_mask:0xc
  v_mul_f32 v100, v100, v5
  v_mul_f32 v101, v101, v5
  v_mul_f32 v102, v102, v5
  v_mul_f32 v103, v103, v5
  v_cvt_pk_bf16_f32 v100, v100, v101
  v_cvt_pk_bf16_f32 v101, v102, v103
  v_mov_b32_dpp v5, v7 row_newbcast:4 row_mask:0xf bank_mask:0x3
  v_mov_b32_dpp v5, v7 row_newbcast:12 row_mask:0xf bank_mask:0xc
  v_mul_f32 v104, v104, v5
  v_mul_f32 v105, v105, v5
  v_mul_f32 v106, v106, v5
  v_mul_f32 v107, v107, v5
  v_cvt_pk_bf16_f32 v104, v104, v105
  v_cvt_pk_bf16_f32 v105, v106, v107
  v_mov_b32_dpp v5, v7 row_newbcast:6 row_mask:0xf bank_mask:0x3
  v_mov_b32_dpp v5, v7 row_newbcast:14 row_mask:0xf bank_mask:0xc
  v_mul_f32 v108, v108, v5
  v_mul_f32 v109, v109, v5
  v_mul_f32 v110, v110, v5
  v_mul_f32 v111, v111, v5
  v_cvt_pk_bf16_f32 v108, v108, v109
  v_cvt_pk_bf16_f32 v109, v110, v111
  v_lshrrev_b32 v4, 1, v22
  s_lshl_b32 s60, s2, 11
  s_add_u32 s60, s60, 1048576
  v_lshlrev_b32 v5, 2, v28
  s_cmp_eq_u32 s69, 1
  s_cbranch_scc1 L_bploc
  buffer_store_dwordx2 v[96:97], v4, s[48:51], s60 offen offset:0 sc1
  buffer_store_dwordx2 v[100:101], v4, s[48:51], s60 offen offset:512 sc1
  buffer_store_dwordx2 v[104:105], v4, s[48:51], s60 offen offset:1024 sc1
  buffer_store_dwordx2 v[108:109], v4, s[48:51], s60 offen offset:1536 sc1
  s_waitcnt vmcnt(0)
  s_mov_b64 exec, 0x5555
  buffer_store_dword v46, v5, s[48:51], s96 offen offset:128 sc1
  s_mov_b64 exec, -1
  s_branch L_bpdone
L_bploc:
  buffer_store_dwordx2 v[96:97], v4, s[48:51], s60 offen offset:0
  buffer_store_dwordx2 v[100:101], v4, s[48:51], s60 offen offset:512
  buffer_store_dwordx2 v[104:105], v4, s[48:51], s60 offen offset:1024
  buffer_store_dwordx2 v[108:109], v4, s[48:51], s60 offen offset:1536
  s_waitcnt vmcnt(0)
  s_mov_b64 exec, 0x5555
  buffer_store_dword v46, v5, s[48:51], s96 offen offset:128
  s_mov_b64 exec, -1
L_bpdone:
  v_mul_u32_u24 v4, 23552, v3
  s_and_b32 s62, s91, 15
  s_lshr_b32 s61, s62, 1
  s_lshl_b32 s61, s61, 2
  s_mul_i32 s60, s64, 2944
  s_add_u32 s60, s60, s61
  s_add_u32 s60, s60, 2097152
  s_mov_b32 s68, 65536
L_l2:
  s_sleep 16
  buffer_load_dword v6, v4, s[48:51], s60 offen offset:128 sc1
  s_waitcnt vmcnt(0)
  v_cmp_eq_u32 s[86:87], -1, v6
  s_nop 0
  s_cmp_eq_u64 s[86:87], 0
  s_cbranch_scc1 L_l2_ok
  s_sleep 16
  s_sub_u32 s68, s68, 1
  s_cmp_lg_u32 s68, 0
  s_cbranch_scc1 L_l2
L_l2_ok:
  v_lshlrev_b32 v5, 14, v3
  v_lshl_add_u32 v5, v2, 4, v5
  s_lshl_b32 s60, s64, 11
  s_lshl_b32 s61, s62, 7
  s_add_u32 s60, s60, s61
  s_add_u32 s60, s60, 1048576
  buffer_load_dwordx4 v[80:83], v5, s[48:51], s60 offen offset:0 sc1
  buffer_load_dwordx4 v[84:87], v5, s[48:51], s60 offen offset:64 sc1
  v_mov_b32 v7, v6
  s_nop 1
  v_max_f32_dpp v7, v7, v7 row_ror:8 row_mask:0xf bank_mask:0xf
  s_nop 1
  v_max_f32_dpp v7, v7, v7 row_ror:4 row_mask:0xf bank_mask:0xf
  s_nop 1
  v_max_f32_dpp v7, v7, v7 row_ror:2 row_mask:0xf bank_mask:0xf
  s_nop 1
  v_max_f32_dpp v7, v7, v7 row_ror:1 row_mask:0xf bank_mask:0xf
  v_sub_f32 v6, v6, v7
  v_exp_f32 v6, v6
  s_nop 0
  v_mov_b32 v7, v6
  s_nop 1
  v_add_f32_dpp v7, v7, v7 row_ror:8 row_mask:0xf bank_mask:0xf
  s_nop 1
  v_add_f32_dpp v7, v7, v7 row_ror:4 row_mask:0xf bank_mask:0xf
  s_nop 1
  v_add_f32_dpp v7, v7, v7 row_ror:2 row_mask:0xf bank_mask:0xf
  s_nop 1
  v_add_f32_dpp v7, v7, v7 row_ror:1 row_mask:0xf bank_mask:0xf
  v_rcp_f32 v7, v7
  s_nop 0
  v_mul_f32 v6, v6, v7
  s_waitcnt vmcnt(0)
  v_lshlrev_b32 v64, 16, v80
  v_and_b32 v65, 0xffff0000, v80
  v_lshlrev_b32 v66, 16, v81
  v_and_b32 v67, 0xffff0000, v81
  v_lshlrev_b32 v68, 16, v82
  v_and_b32 v69, 0xffff0000, v82
  v_lshlrev_b32 v70, 16, v83
  v_and_b32 v71, 0xffff0000, v83
  v_lshlrev_b32 v72, 16, v84
  v_and_b32 v73, 0xffff0000, v84
  v_lshlrev_b32 v74, 16, v85
  v_and_b32 v75, 0xffff0000, v85
  v_lshlrev_b32 v76, 16, v86
  v_and_b32 v77, 0xffff0000, v86
  v_lshlrev_b32 v78, 16, v87
  v_and_b32 v79, 0xffff0000, v87
  v_mul_f32 v64, v64, v6
  v_mul_f32 v65, v65, v6
  v_mul_f32 v66, v66, v6
  v_mul_f32 v67, v67, v6
  v_mul_f32 v68, v68, v6
  v_mul_f32 v69, v69, v6
  v_mul_f32 v70, v70, v6
  v_mul_f32 v71, v71, v6
  v_mul_f32 v72, v72, v6
  v_mul_f32 v73, v73, v6
  v_mul_f32 v74, v74, v6
  v_mul_f32 v75, v75, v6
  v_mul_f32 v76, v76, v6
  v_mul_f32 v77, v77, v6
  v_mul_f32 v78, v78, v6
  v_mul_f32 v79, v79, v6
  v_add_f32_dpp v64, v64, v64 row_ror:8 row_mask:0xf bank_mask:0xf
  v_add_f32_dpp v65, v65, v65 row_ror:8 row_mask:0xf bank_mask:0xf
  v_add_f32_dpp v66, v66, v66 row_ror:8 row_mask:0xf bank_mask:0xf
  v_add_f32_dpp v67, v67, v67 row_ror:8 row_mask:0xf bank_mask:0xf
  v_add_f32_dpp v68, v68, v68 row_ror:8 row_mask:0xf bank_mask:0xf
  v_add_f32_dpp v69, v69, v69 row_ror:8 row_mask:0xf bank_mask:0xf
  v_add_f32_dpp v70, v70, v70 row_ror:8 row_mask:0xf bank_mask:0xf
  v_add_f32_dpp v71, v71, v71 row_ror:8 row_mask:0xf bank_mask:0xf
  v_add_f32_dpp v72, v72, v72 row_ror:8 row_mask:0xf bank_mask:0xf
  v_add_f32_dpp v73, v73, v73 row_ror:8 row_mask:0xf bank_mask:0xf
  v_add_f32_dpp v74, v74, v74 row_ror:8 row_mask:0xf bank_mask:0xf
  v_add_f32_dpp v75, v75, v75 row_ror:8 row_mask:0xf bank_mask:0xf
  v_add_f32_dpp v76, v76, v76 row_ror:8 row_mask:0xf bank_mask:0xf
  v_add_f32_dpp v77, v77, v77 row_ror:8 row_mask:0xf bank_mask:0xf
  v_add_f32_dpp v78, v78, v78 row_ror:8 row_mask:0xf bank_mask:0xf
  v_add_f32_dpp v79, v79, v79 row_ror:8 row_mask:0xf bank_mask:0xf
  v_add_f32_dpp v64, v64, v64 row_ror:4 row_mask:0xf bank_mask:0xf
  v_add_f32_dpp v65, v65, v65 row_ror:4 row_mask:0xf bank_mask:0xf
  v_add_f32_dpp v66, v66, v66 row_ror:4 row_mask:0xf bank_mask:0xf
  v_add_f32_dpp v67, v67, v67 row_ror:4 row_mask:0xf bank_mask:0xf
  v_add_f32_dpp v68, v68, v68 row_ror:4 row_mask:0xf bank_mask:0xf
  v_add_f32_dpp v69, v69, v69 row_ror:4 row_mask:0xf bank_mask:0xf
  v_add_f32_dpp v70, v70, v70 row_ror:4 row_mask:0xf bank_mask:0xf
  v_add_f32_dpp v71, v71, v71 row_ror:4 row_mask:0xf bank_mask:0xf
  v_add_f32_dpp v72, v72, v72 row_ror:4 row_mask:0xf bank_mask:0xf
  v_add_f32_dpp v73, v73, v73 row_ror:4 row_mask:0xf bank_mask:0xf
  v_add_f32_dpp v74, v74, v74 row_ror:4 row_mask:0xf bank_mask:0xf
  v_add_f32_dpp v75, v75, v75 row_ror:4 row_mask:0xf bank_mask:0xf
  v_add_f32_dpp v76, v76, v76 row_ror:4 row_mask:0xf bank_mask:0xf
  v_add_f32_dpp v77, v77, v77 row_ror:4 row_mask:0xf bank_mask:0xf
  v_add_f32_dpp v78, v78, v78 row_ror:4 row_mask:0xf bank_mask:0xf
  v_add_f32_dpp v79, v79, v79 row_ror:4 row_mask:0xf bank_mask:0xf
  v_add_f32_dpp v64, v64, v64 row_ror:2 row_mask:0xf bank_mask:0xf
  v_add_f32_dpp v65, v65, v65 row_ror:2 row_mask:0xf bank_mask:0xf
  v_add_f32_dpp v66, v66, v66 row_ror:2 row_mask:0xf bank_mask:0xf
  v_add_f32_dpp v67, v67, v67 row_ror:2 row_mask:0xf bank_mask:0xf
  v_add_f32_dpp v68, v68, v68 row_ror:2 row_mask:0xf bank_mask:0xf
  v_add_f32_dpp v69, v69, v69 row_ror:2 row_mask:0xf bank_mask:0xf
  v_add_f32_dpp v70, v70, v70 row_ror:2 row_mask:0xf bank_mask:0xf
  v_add_f32_dpp v71, v71, v71 row_ror:2 row_mask:0xf bank_mask:0xf
  v_add_f32_dpp v72, v72, v72 row_ror:2 row_mask:0xf bank_mask:0xf
  v_add_f32_dpp v73, v73, v73 row_ror:2 row_mask:0xf bank_mask:0xf
  v_add_f32_dpp v74, v74, v74 row_ror:2 row_mask:0xf bank_mask:0xf
  v_add_f32_dpp v75, v75, v75 row_ror:2 row_mask:0xf bank_mask:0xf
  v_add_f32_dpp v76, v76, v76 row_ror:2 row_mask:0xf bank_mask:0xf
  v_add_f32_dpp v77, v77, v77 row_ror:2 row_mask:0xf bank_mask:0xf
  v_add_f32_dpp v78, v78, v78 row_ror:2 row_mask:0xf bank_mask:0xf
  v_add_f32_dpp v79, v79, v79 row_ror:2 row_mask:0xf bank_mask:0xf
  v_add_f32_dpp v64, v64, v64 row_ror:1 row_mask:0xf bank_mask:0xf
  v_add_f32_dpp v65, v65, v65 row_ror:1 row_mask:0xf bank_mask:0xf
  v_add_f32_dpp v66, v66, v66 row_ror:1 row_mask:0xf bank_mask:0xf
  v_add_f32_dpp v67, v67, v67 row_ror:1 row_mask:0xf bank_mask:0xf
  v_add_f32_dpp v68, v68, v68 row_ror:1 row_mask:0xf bank_mask:0xf
  v_add_f32_dpp v69, v69, v69 row_ror:1 row_mask:0xf bank_mask:0xf
  v_add_f32_dpp v70, v70, v70 row_ror:1 row_mask:0xf bank_mask:0xf
  v_add_f32_dpp v71, v71, v71 row_ror:1 row_mask:0xf bank_mask:0xf
  v_add_f32_dpp v72, v72, v72 row_ror:1 row_mask:0xf bank_mask:0xf
  v_add_f32_dpp v73, v73, v73 row_ror:1 row_mask:0xf bank_mask:0xf
  v_add_f32_dpp v74, v74, v74 row_ror:1 row_mask:0xf bank_mask:0xf
  v_add_f32_dpp v75, v75, v75 row_ror:1 row_mask:0xf bank_mask:0xf
  v_add_f32_dpp v76, v76, v76 row_ror:1 row_mask:0xf bank_mask:0xf
  v_add_f32_dpp v77, v77, v77 row_ror:1 row_mask:0xf bank_mask:0xf
  v_add_f32_dpp v78, v78, v78 row_ror:1 row_mask:0xf bank_mask:0xf
  v_add_f32_dpp v79, v79, v79 row_ror:1 row_mask:0xf bank_mask:0xf
  s_mov_b32 s86, 0x10001
  s_mov_b32 s87, 0x10001
  v_cvt_pk_bf16_f32 v80, v64, v65
  v_min_u32 v80, -2, v80
  v_cndmask_b32 v80, 0, v80, s[86:87]
  v_cvt_pk_bf16_f32 v81, v66, v67
  v_min_u32 v81, -2, v81
  v_cndmask_b32 v81, 0, v81, s[86:87]
  v_cvt_pk_bf16_f32 v82, v68, v69
  v_min_u32 v82, -2, v82
  v_cndmask_b32 v82, 0, v82, s[86:87]
  v_cvt_pk_bf16_f32 v83, v70, v71
  v_min_u32 v83, -2, v83
  v_cndmask_b32 v83, 0, v83, s[86:87]
  v_cvt_pk_bf16_f32 v84, v72, v73
  v_min_u32 v84, -2, v84
  v_cndmask_b32 v84, 0, v84, s[86:87]
  v_cvt_pk_bf16_f32 v85, v74, v75
  v_min_u32 v85, -2, v85
  v_cndmask_b32 v85, 0, v85, s[86:87]
  v_cvt_pk_bf16_f32 v86, v76, v77
  v_min_u32 v86, -2, v86
  v_cndmask_b32 v86, 0, v86, s[86:87]
  v_cvt_pk_bf16_f32 v87, v78, v79
  v_min_u32 v87, -2, v87
  v_cndmask_b32 v87, 0, v87, s[86:87]
  v_xor_b32 v4, s62, v3
  v_and_b32 v4, 1, v4
  v_lshlrev_b32 v4, 7, v4
  v_lshl_add_u32 v4, v2, 4, v4
  s_mov_b32 s86, 0x30003
  s_mov_b32 s87, 0x30003
  s_mov_b64 exec, s[86:87]
  buffer_store_dwordx4 v[80:83], v4, s[48:51], s96 offen offset:640 sc1
  buffer_store_dwordx4 v[84:87], v4, s[48:51], s96 offen offset:704 sc1
  s_mov_b64 exec, -1
  v_mov_b32 v20, 0
  s_mul_i32 s101, s92, 3840
  s_add_u32 s101, s101, 1605632
  s_lshl_b32 s65, s91, 1
  s_add_u32 s65, s65, s101
  s_mov_b32 s99, 1605760
  v_mov_b32 v30, 156224
  v_lshlrev_b32 v31, 1, v1
  s_mov_b32 s100, 5
L_cloop:
  s_lshl_b32 s62, s100, 2
  s_mov_b32 s68, 65536
L_cw:
  ds_read_b128 v[32:35], v30
  s_waitcnt lgkmcnt(0)
  v_add3_u32 v32, v32, v33, v34
  v_add3_u32 v32, v32, v35, 1
  s_nop 0
  v_readfirstlane_b32 s60, v32
  s_nop 0
  s_cmp_ge_u32 s60, s62
  s_cbranch_scc1 L_cw_ok
  s_sleep 4
  s_sub_u32 s68, s68, 1
  s_cmp_lg_u32 s68, 0
  s_cbranch_scc1 L_cw
L_cw_ok:
  s_add_u32 s63, s100, 1
  v_mov_b32 v32, s63
  buffer_load_ushort v34, v31, s[48:51], s101 offen sc1
  s_mov_b64 exec, 1
  buffer_store_short v32, v20, s[48:51], s65 offen
  s_mov_b64 exec, -1
  s_waitcnt vmcnt(0)
  v_cmp_lt_u32 s[86:87], s100, v34
  s_nop 0
  s_bcnt1_i32_b32 s60, s86
  s_mov_b32 s61, 0
  v_cmp_lt_u32 s[86:87], s63, v34
  s_nop 0
  s_bcnt1_i32_b32 s62, s86
  s_add_u32 s61, s61, s62
  s_add_u32 s63, s63, 1
  v_readlane_b32 s62, v34, 32
  s_nop 0
  s_min_u32 s62, s62, 7
  s_mul_i32 s62, s62, 3
  s_add_u32 s61, s61, s62
  s_add_u32 s61, s60, s61
  s_mov_b32 s62, 0
  s_cmp_ge_u32 s61, 28
  s_cselect_b32 s62, 1, s62
  s_cmp_ge_u32 s61, 40
  s_cselect_b32 s62, 2, s62
  v_mov_b32 v33, s62
  ds_write_b32 v30, v33 offset:16
  s_and_b32 s62, s100, 0
  s_cbranch_scc1 L_nrep
  s_add_u32 s99, s99, 1280
  s_cmp_lg_u32 s60, 15
  s_cbranch_scc1 L_nrep
  v_mov_b32 v32, 1
  s_mov_b64 exec, 1
  buffer_atomic_add v32, v20, s[48:51], s99 offen sc0 sc1
  s_waitcnt vmcnt(0)
  buffer_store_short v32, v20, s[48:51], s101 offen offset:64
  s_mov_b64 exec, -1
L_nrep:
  s_add_u32 s100, s100, 1
  s_cmp_lg_u32 s100, 15
  s_cbranch_scc1 L_na
  v_and_b32 v4, 3, v1
  v_lshlrev_b32 v5, 3, v4
  v_add_u32 v5, 156160, v5
  s_mov_b32 s68, 65536
L_st:
  ds_read_b64 v[58:59], v5
  s_waitcnt lgkmcnt(0)
  v_max_u32 v6, v58, v59
  v_cmp_eq_u32 s[86:87], -1, v6
  s_nop 0
  s_cmp_eq_u64 s[86:87], 0
  s_cbranch_scc1 L_st_ok
  s_sleep 16
  s_sub_u32 s68, s68, 1
  s_cmp_lg_u32 s68, 0
  s_cbranch_scc1 L_st
L_st_ok:
  v_mov_b32 v60, v58
  s_nop 1
  v_max_f32_dpp v60, v60, v60 quad_perm:[1,0,3,2] row_mask:0xf bank_mask:0xf
  s_nop 1
  v_max_f32_dpp v60, v60, v60 quad_perm:[2,3,0,1] row_mask:0xf bank_mask:0xf
  v_sub_f32 v6, v58, v60
  v_exp_f32 v6, v6
  s_nop 0
  v_mul_f32 v61, v6, v59
  s_nop 1
  v_add_f32_dpp v61, v61, v61 quad_perm:[1,0,3,2] row_mask:0xf bank_mask:0xf
  s_nop 1
  v_add_f32_dpp v61, v61, v61 quad_perm:[2,3,0,1] row_mask:0xf bank_mask:0xf
  v_min_u32 v6, -2, v60
  v_min_u32 v7, -2, v61
  s_mov_b64 exec, 1
  buffer_store_dwordx2 v[6:7], v20, s[48:51], s96 offen offset:256 sc1
  s_mov_b64 exec, -1
L_na:
  s_cmp_lg_u32 s100, 20
  s_cbranch_scc1 L_nw
  s_xor_b32 s60, s2, 1
  s_mul_i32 s60, s60, 2944
  s_add_u32 s60, s60, 2097152
  s_mov_b32 s68, 65536
L_ps:
  buffer_load_dwordx2 v[36:37], v20, s[48:51], s60 offen offset:256 sc1
  s_waitcnt vmcnt(0)
  v_max_u32 v6, v36, v37
  v_cmp_eq_u32 s[86:87], -1, v6
  s_nop 0
  s_cmp_eq_u64 s[86:87], 0
  s_cbranch_scc1 L_ps_ok
  s_sleep 16
  s_sub_u32 s68, s68, 1
  s_cmp_lg_u32 s68, 0
  s_cbranch_scc1 L_ps
L_ps_ok:
  v_max_f32 v4, v60, v36
  v_sub_f32 v5, v60, v4
  v_sub_f32 v6, v36, v4
  v_sub_f32 v7, v58, v4
  v_exp_f32 v5, v5
  v_exp_f32 v6, v6
  v_exp_f32 v7, v7
  v_mul_f32 v5, v5, v61
  v_fmac_f32 v5, v6, v37
  v_rcp_f32 v5, v5
  s_nop 0
  v_mul_f32 v7, v7, v5
  v_and_b32 v4, 3, v1
  v_lshlrev_b32 v4, 2, v4
  v_add_u32 v4, 156192, v4
  ds_write_b32 v4, v7
L_nw:
  s_cmp_le_u32 s100, 25
  s_cbranch_scc1 L_cloop
  s_waitcnt vmcnt(0) lgkmcnt(0)
L_end:
  s_endpgm
.section .rodata,"a"
.p2align 6
.amdhsa_kernel concat_heads__mha_block_cached__sliding_block_cached__decode_kernel
  .amdhsa_next_free_vgpr 256
  .amdhsa_next_free_sgpr 102
  .amdhsa_accum_offset 128
  .amdhsa_group_segment_fixed_size 0
  .amdhsa_kernarg_size 104
  .amdhsa_user_sgpr_count 2
  .amdhsa_user_sgpr_kernarg_segment_ptr 1
  .amdhsa_system_sgpr_workgroup_id_x 1
  .amdhsa_float_denorm_mode_32 3
.end_amdhsa_kernel
```
